```python
import torch

def _softmax(x, axis=-1):
    return torch.softmax(x, dim=axis)
def _gelu(x):
    return torch.nn.functional.gelu(x, approximate="tanh")
def _silu(x):
    return torch.nn.functional.silu(x)
def _sigmoid(x):
    return torch.sigmoid(x)
def _layernorm(x, axis=-1, eps=1e-5):
    m = x.mean(dim=axis, keepdim=True)
    v = x.var(dim=axis, keepdim=True, unbiased=False)
    return (x - m) / torch.sqrt(v + eps)
def _scatter_add(tgt, idx, src, axis=0):
    return tgt.clone().index_add_(axis, idx, src)
def _segment_sum(src, seg, n):
    out = torch.zeros((n,) + src.shape[1:], dtype=src.dtype)
    return out.index_add_(0, seg, src)
def _pad(x, pw):
    flat = tuple(v for pair in reversed(pw) for v in pair)
    return torch.nn.functional.pad(x, flat)

kernel_name = 'recurrent_scan__softmax_full_mha__glu_gated_geglu__prompt'

def setup_inputs():

    _w = (lambda a: (lambda t: t.to(torch.bfloat16) if t.is_floating_point() else t)(torch.as_tensor(a)))
    def _A_setup():
        B, S, D = 1, 2048, 512
        return {
            "x": _w((lambda *s: torch.randn(*s, dtype=torch.bfloat16) * 0.05)(B, S, D)),
            "wqkv": _w((lambda *s: torch.randn(*s, dtype=torch.bfloat16) * 0.2)(D, 3 * D)),
            "wo": _w((lambda *s: torch.randn(*s, dtype=torch.bfloat16) * 0.2)(D, D)),
        }
    _A_in = _A_setup()

    def _B_setup():
        B, S, Dm, Df = 1, 2048, 512, 1376
        return {
            "x": _w((lambda *s: torch.randn(*s, dtype=torch.bfloat16) * 0.05)(B, S, Dm)),
            "w_gate": _w((lambda *s: torch.randn(*s, dtype=torch.bfloat16) * 0.1)(Dm, Df) * (Dm ** -0.5)),
            "w_up": _w((lambda *s: torch.randn(*s, dtype=torch.bfloat16) * 0.1)(Dm, Df) * (Dm ** -0.5)),
            "w_down": _w((lambda *s: torch.randn(*s, dtype=torch.bfloat16) * 0.1)(Df, Dm) * (Df ** -0.5)),
        }
    _B_in = _B_setup()

    return {
        "A_x": _A_in["x"],
        "A_wqkv": _A_in["wqkv"],
        "A_wo": _A_in["wo"],
        "B_x": _B_in["x"],
        "B_w_gate": _B_in["w_gate"],
        "B_w_up": _B_in["w_up"],
        "B_w_down": _B_in["w_down"],
    }

def reference(A_x, A_wqkv, A_wo, B_x, B_w_gate, B_w_up, B_w_down):
    def _A_ref(x, wqkv, wo):
        B, S, D = x.shape
        H = 32; Dh = D // H
        qkv = (lambda x, *d: x.permute(*d))((x @ wqkv).reshape(B, S, 3, H, Dh), 2, 0, 3, 1, 4)
        q, k, v = qkv[0], qkv[1], qkv[2]
        scale = Dh ** -0.5
        scores = torch.einsum("bhqd,bhkd->bhqk", q, k) * scale
        p = _softmax(scores, axis=-1)
        o = torch.einsum("bhqk,bhkd->bhqd", p, v)
        return (lambda x, *d: x.permute(*d))(o, 0, 2, 1, 3).reshape(B, S, D) @ wo

    def _B_ref(x, w_gate, w_up, w_down):
        g = torch.einsum("bsd,df->bsf", x, w_gate)
        u = torch.einsum("bsd,df->bsf", x, w_up)
        h = _gelu(g) * u
        return torch.einsum("bsf,fd->bsd", h, w_down)

    x = A_x
    xn = _layernorm(x, axis=-1)
    s = _A_ref(xn, A_wqkv, A_wo)
    g = _silu(_B_ref(xn, B_w_gate, B_w_up, B_w_down))
    return x + s * g
```

```asm
; @launch grid=(256,1,1) block=(512,1,1) lds=163328
.amdgcn_target "amdgcn-amd-amdhsa--gfx950"
.text
.globl recurrent_scan__softmax_full_mha__glu_gated_geglu__prompt_kernel
.p2align 8
.type recurrent_scan__softmax_full_mha__glu_gated_geglu__prompt_kernel,@function
recurrent_scan__softmax_full_mha__glu_gated_geglu__prompt_kernel:
    s_cmp_ge_u32 s2, 256
    s_cbranch_scc1 L_end
    s_load_dwordx4 s[4:7], s[0:1], 0
    s_load_dwordx2 s[24:25], s[0:1], 16
    s_load_dwordx4 s[16:19], s[0:1], 32
    s_load_dwordx4 s[20:23], s[0:1], 48
    s_load_dwordx4 s[36:39], s[0:1], 64
    s_getpc_b64 s[8:9]
    s_lshr_b32 s10, s2, 3
    s_lshl_b32 s10, s10, 7
    s_add_u32 s8, s8, s10
    s_addc_u32 s9, s9, 0
    v_lshlrev_b32 v2, 12, v0
    v_add_co_u32 v2, vcc, s8, v2
    v_mov_b32 v3, s9
    v_cmp_gt_u32 s[10:11], 12, v0
    v_addc_co_u32 v3, vcc, 0, v3, vcc
    s_and_saveexec_b64 s[12:13], s[10:11]
    s_cbranch_execz L_nocpf
    global_load_dword v143, v[2:3], off
    L_nocpf:
    s_mov_b64 exec, -1
    v_lshrrev_b32 v2, 6, v0
    v_and_b32 v1, 63, v0
    s_and_b32 s43, s2, 7
    v_readfirstlane_b32 s40, v2
    s_lshr_b32 s44, s2, 3
    s_lshr_b32 s41, s43, 1
    s_lshl_b32 s41, s41, 3
    s_and_b32 s45, s44, 7
    s_add_u32 s41, s41, s45
    s_and_b32 s42, s43, 1
    s_lshl_b32 s42, s42, 2
    s_lshr_b32 s45, s44, 3
    s_add_u32 s42, s42, s45
    v_lshrrev_b32 v2, 3, v1
    v_and_b32 v3, 7, v1
    v_lshlrev_b32 v4, 10, v2
    v_lshl_add_u32 v5, v3, 4, v4
    s_lshl_b32 s43, s41, 16
    s_lshl_b32 s44, s40, 13
    s_add_u32 s43, s43, s44
    s_mov_b32 s10, 2097152
    s_mov_b32 s11, 0x00020000
    s_mov_b32 s14, 1572864
    s_mov_b32 s15, 0x00020000
    s_and_b32 s48, s40, 3
    s_and_b32 s49, s48, 1
    v_lshlrev_b32 v21, 4, v1
    s_lshl_b32 s44, s48, 2
    s_add_u32 s44, s44, 158976
    v_lshlrev_b32 v18, 2, v1
    v_add_u32 v18, 159232, v18
    v_writelane_b32 v18, s44, 0
    v_mov_b32 v19, 1
    v_and_b32 v22, 3, v1
    v_lshlrev_b32 v0, 2, v22
    v_add_u32 v0, 158976, v0
    s_mov_b32 s47, 200000
    s_waitcnt lgkmcnt(0)
    s_mov_b32 s8, s4
    s_mov_b32 s9, s5
    s_mov_b32 s12, s6
    s_mov_b32 s13, s7
    buffer_load_dwordx4 v[40:43], v5, s[8:11], s43 offen offset:0
    buffer_load_dwordx4 v[44:47], v5, s[8:11], s43 offen offset:128
    buffer_load_dwordx4 v[48:51], v5, s[8:11], s43 offen offset:256
    buffer_load_dwordx4 v[52:55], v5, s[8:11], s43 offen offset:384
    buffer_load_dwordx4 v[56:59], v5, s[8:11], s43 offen offset:512
    buffer_load_dwordx4 v[60:63], v5, s[8:11], s43 offen offset:640
    buffer_load_dwordx4 v[64:67], v5, s[8:11], s43 offen offset:768
    buffer_load_dwordx4 v[68:71], v5, s[8:11], s43 offen offset:896
    s_mov_b32 s28, s38
    s_mov_b32 s29, s39
    s_mov_b32 s30, 33554432
    s_mov_b32 s31, 0x00020000
    s_mov_b32 s38, 256
    s_mov_b32 s39, 0x00020000
    s_bitcmp1_b32 s40, 1
    s_cselect_b32 s16, s18, s16
    s_cselect_b32 s17, s19, s17
    s_mov_b32 s18, 1409024
    s_mov_b32 s19, 0x00020000
    v_lshlrev_b32 v4, 1, v2
    v_and_b32 v4, 4, v4
    v_xor_b32 v4, v4, v3
    v_lshlrev_b32 v5, 4, v4
    s_lshl_b32 s51, s48, 12
    s_add_u32 s51, s51, 9472
    s_mul_i32 s59, s42, 3
    s_add_u32 s44, s42, 1
    s_lshr_b32 s44, s44, 2
    s_sub_u32 s59, s59, s44
    v_mul_u32_u24 v6, 3072, v2
    v_add_u32 v6, v6, v5
    v_add_u32 v7, 23552, v6
    s_mul_i32 s52, s48, 98304
    s_lshl_b32 s45, s42, 7
    s_add_u32 s52, s52, s45
    s_cmp_lt_u32 s40, 4
    s_cbranch_scc1 L_pre_a
    v_bfe_u32 v20, v1, 2, 2
    v_mul_u32_u24 v20, 3072, v20
    v_lshl_add_u32 v20, v22, 7, v20
    v_lshrrev_b32 v24, 4, v1
    v_lshl_add_u32 v20, v24, 10, v20
    s_lshr_b32 s44, s2, 3
    s_mul_i32 s44, s44, 49152
    s_mul_i32 s43, s48, 12288
    s_add_u32 s44, s44, s43
    s_and_b32 s43, s2, 1
    s_lshl_b32 s43, s43, 9
    s_add_u32 s44, s44, s43
    s_lshr_b32 s50, s48, 1
    v_bfe_u32 v4, v1, 2, 2
    v_lshlrev_b32 v14, 7, v4
    v_bfe_u32 v24, v1, 4, 1
    v_lshl_add_u32 v14, v24, 5, v14
    v_lshl_add_u32 v14, v22, 3, v14
    v_lshrrev_b32 v26, 1, v4
    v_lshrrev_b32 v27, 5, v1
    v_xor_b32 v22, s50, v26
    v_lshl_add_u32 v12, v22, 6, v14
    v_lshl_add_u32 v12, v27, 10, v12
    v_add_u32 v12, 9472, v12
    v_add_u32 v13, 65536, v12
    v_and_b32 v29, 31, v1
    v_mul_u32_u24 v31, 528, v27
    v_lshl_add_u32 v31, v29, 4, v31
    s_mul_i32 s43, s49, 33792
    s_add_u32 s43, s43, 91392
    v_add_u32 v31, s43, v31
    s_mov_b64 exec, 0xffffffff
    buffer_load_dword v143, v20, s[12:15], s44 offen offset:1024
    s_mov_b64 exec, -1
    s_lshl_b32 s69, s41, 11
    s_lshl_b32 s43, s49, 10
    s_add_u32 s69, s69, s43
    s_lshl_b32 s43, s42, 18
    s_add_u32 s69, s69, s43
    s_lshl_b32 s43, s50, 17
    s_add_u32 s69, s69, s43
    s_add_u32 s65, s69, 65536
    v_mov_b32 v136, -1
    v_mov_b32 v137, -1
    v_mov_b32 v138, -1
    v_mov_b32 v139, -1
    v_lshlrev_b32 v140, 13, v27
    v_lshl_add_u32 v140, v29, 2, v140
    s_lshr_b32 s0, s69, 3
    s_add_u32 s0, s0, 27262976
    s_mov_b32 s3, 1
    s_setprio 1
    s_add_u32 m0, s51, 0
    s_add_u32 s64, s52, 1024
    buffer_load_dwordx4 v6, s[12:15], s64 offen lds
    buffer_load_dwordx4 v7, s[12:15], s64 offen offset:1024 lds
    s_add_u32 s64, s52, 48128
    buffer_load_dwordx4 v6, s[12:15], s64 offen offset:2048 lds
    buffer_load_dwordx4 v7, s[12:15], s64 offen offset:3072 lds
    s_add_u32 m0, s51, 16384
    s_add_u32 s64, s52, 394240
    buffer_load_dwordx4 v6, s[12:15], s64 offen lds
    buffer_load_dwordx4 v7, s[12:15], s64 offen offset:1024 lds
    s_add_u32 s64, s52, 441344
    buffer_load_dwordx4 v6, s[12:15], s64 offen offset:2048 lds
    buffer_load_dwordx4 v7, s[12:15], s64 offen offset:3072 lds
    s_waitcnt vmcnt(9)
    s_branch L_ln
L_pre_a:
    v_mov_b32 v15, 0
    ds_write_b32 v18, v15
    ds_write_b32 v18, v15 offset:512
    ds_write_b32 v18, v15 offset:1024
    v_add_u32 v18, 1024, v18
    v_lshlrev_b32 v29, 2, v1
    s_lshl_b32 s43, s40, 9
    s_add_u32 s43, s43, 161024
    v_add_u32 v13, s43, v29
    s_xor_b32 s43, s40, 2
    s_lshl_b32 s43, s43, 9
    s_add_u32 s43, s43, 161024
    v_add_u32 v14, s43, v29
    v_add_u32 v29, 163072, v29
    ds_write_b32 v13, v15
    ds_write_b32 v13, v15 offset:256
    ds_write_b32 v29, v15
    v_bfe_u32 v26, v1, 2, 2
    v_mul_u32_u24 v26, 3072, v26
    v_lshl_add_u32 v26, v22, 7, v26
    v_bfe_u32 v25, v1, 4, 1
    v_xor_b32 v25, 1, v25
    v_lshl_add_u32 v26, v25, 11, v26
    s_lshr_b32 s7, s2, 3
    s_lshl_b32 s7, s7, 2
    s_add_u32 s7, s7, s40
    s_mul_i32 s7, s7, 12288
    s_and_b32 s43, s2, 1
    s_lshl_b32 s43, s43, 9
    s_add_u32 s7, s7, s43
    s_and_b32 s43, s42, 3
    s_cmp_eq_u32 s43, 3
    s_addc_u32 s59, s59, 0
    v_lshrrev_b32 v30, 1, v1
    v_mul_u32_u24 v30, 2752, v30
    v_and_b32 v31, 1, v1
    v_mul_u32_u24 v31, 124, v31
    v_add_u32 v30, v30, v31
    s_and_b32 s68, s41, 7
    s_lshl_b32 s68, s68, 1
    s_add_u32 s68, s68, s49
    s_mul_i32 s68, s68, 44032
    s_lshl_b32 s43, s59, 7
    s_add_u32 s68, s68, s43
    s_lshr_b32 s60, s2, 5
    s_lshl_b32 s60, s60, 1
    s_add_u32 s60, s60, s49
    s_lshl_b32 s60, s60, 1
    s_lshr_b32 s43, s40, 1
    s_add_u32 s60, s60, s43
    s_lshl_b32 s60, s60, 16
    s_and_b32 s43, s2, 7
    s_lshl_b32 s43, s43, 12
    s_add_u32 s60, s60, s43
    s_bfe_u32 s43, s2, 0x20003
    s_lshl_b32 s43, s43, 10
    s_add_u32 s60, s60, s43
    s_add_u32 s60, s60, 6291456
    s_or_b32 s44, s2, s40
    s_cmp_lg_u32 s44, 0
    s_cbranch_scc1 L_pre_a2
    s_memrealtime s[4:5]
    s_waitcnt lgkmcnt(0)
    s_or_b32 s4, s4, 1
    v_mov_b32 v12, s4
    buffer_store_dword v12, v15, s[36:39], 0 offen sc1
L_pre_a2:
    s_mov_b32 s3, 0
    s_waitcnt vmcnt(0)
L_ln:
    s_mov_b32 s4, 0x3f803f80
    s_mov_b32 s5, 0x00003f80
    s_mov_b32 s6, 0x3f800000
    v_dot2_f32_bf16 v104, v40, s4, 0
    v_dot2_f32_bf16 v106, v40, v40, 0
    v_dot2_f32_bf16 v105, v41, s4, 0
    v_dot2_f32_bf16 v107, v41, v41, 0
    v_dot2_f32_bf16 v104, v42, s4, v104
    v_dot2_f32_bf16 v106, v42, v42, v106
    v_dot2_f32_bf16 v105, v43, s4, v105
    v_dot2_f32_bf16 v107, v43, v43, v107
    v_dot2_f32_bf16 v104, v44, s4, v104
    v_dot2_f32_bf16 v106, v44, v44, v106
    v_dot2_f32_bf16 v105, v45, s4, v105
    v_dot2_f32_bf16 v107, v45, v45, v107
    v_dot2_f32_bf16 v104, v46, s4, v104
    v_dot2_f32_bf16 v106, v46, v46, v106
    v_dot2_f32_bf16 v105, v47, s4, v105
    v_dot2_f32_bf16 v107, v47, v47, v107
    v_dot2_f32_bf16 v104, v48, s4, v104
    v_dot2_f32_bf16 v106, v48, v48, v106
    v_dot2_f32_bf16 v105, v49, s4, v105
    v_dot2_f32_bf16 v107, v49, v49, v107
    v_dot2_f32_bf16 v104, v50, s4, v104
    v_dot2_f32_bf16 v106, v50, v50, v106
    v_dot2_f32_bf16 v105, v51, s4, v105
    v_dot2_f32_bf16 v107, v51, v51, v107
    v_dot2_f32_bf16 v104, v52, s4, v104
    v_dot2_f32_bf16 v106, v52, v52, v106
    v_dot2_f32_bf16 v105, v53, s4, v105
    v_dot2_f32_bf16 v107, v53, v53, v107
    v_dot2_f32_bf16 v104, v54, s4, v104
    v_dot2_f32_bf16 v106, v54, v54, v106
    v_dot2_f32_bf16 v105, v55, s4, v105
    v_dot2_f32_bf16 v107, v55, v55, v107
    v_dot2_f32_bf16 v104, v56, s4, v104
    v_dot2_f32_bf16 v106, v56, v56, v106
    v_dot2_f32_bf16 v105, v57, s4, v105
    v_dot2_f32_bf16 v107, v57, v57, v107
    v_dot2_f32_bf16 v104, v58, s4, v104
    v_dot2_f32_bf16 v106, v58, v58, v106
    v_dot2_f32_bf16 v105, v59, s4, v105
    v_dot2_f32_bf16 v107, v59, v59, v107
    v_dot2_f32_bf16 v104, v60, s4, v104
    v_dot2_f32_bf16 v106, v60, v60, v106
    v_dot2_f32_bf16 v105, v61, s4, v105
    v_dot2_f32_bf16 v107, v61, v61, v107
    v_dot2_f32_bf16 v104, v62, s4, v104
    v_dot2_f32_bf16 v106, v62, v62, v106
    v_dot2_f32_bf16 v105, v63, s4, v105
    v_dot2_f32_bf16 v107, v63, v63, v107
    v_dot2_f32_bf16 v104, v64, s4, v104
    v_dot2_f32_bf16 v106, v64, v64, v106
    v_dot2_f32_bf16 v105, v65, s4, v105
    v_dot2_f32_bf16 v107, v65, v65, v107
    v_dot2_f32_bf16 v104, v66, s4, v104
    v_dot2_f32_bf16 v106, v66, v66, v106
    v_dot2_f32_bf16 v105, v67, s4, v105
    v_dot2_f32_bf16 v107, v67, v67, v107
    v_dot2_f32_bf16 v104, v68, s4, v104
    v_dot2_f32_bf16 v106, v68, v68, v106
    v_dot2_f32_bf16 v105, v69, s4, v105
    v_dot2_f32_bf16 v107, v69, v69, v107
    v_dot2_f32_bf16 v104, v70, s4, v104
    v_dot2_f32_bf16 v106, v70, v70, v106
    v_dot2_f32_bf16 v105, v71, s4, v105
    v_dot2_f32_bf16 v107, v71, v71, v107
    s_lshr_b32 s43, s40, 2
    s_mul_i32 s43, s43, 33792
    s_lshl_b32 s44, s48, 7
    v_add_f32 v104, v104, v105
    v_add_f32 v106, v106, v107
    s_add_u32 s43, s43, s44
    v_add_f32_dpp v104, v104, v104 quad_perm:[1,0,3,2] row_mask:0xf bank_mask:0xf
    v_add_f32_dpp v106, v106, v106 quad_perm:[1,0,3,2] row_mask:0xf bank_mask:0xf
    s_add_u32 s43, s43, 91392
    v_add_f32_dpp v104, v104, v104 quad_perm:[2,3,0,1] row_mask:0xf bank_mask:0xf
    v_add_f32_dpp v106, v106, v106 quad_perm:[2,3,0,1] row_mask:0xf bank_mask:0xf
    v_mul_u32_u24 v112, 528, v3
    v_add_f32_dpp v104, v104, v104 row_half_mirror row_mask:0xf bank_mask:0xf
    v_add_f32_dpp v106, v106, v106 row_half_mirror row_mask:0xf bank_mask:0xf
    v_mul_f32 v104, 0x3b000000, v104
    v_mul_f32 v106, 0x3b000000, v106
    v_cvt_pk_bf16_f32 v108, v104, v104
    v_fma_f32 v106, -v104, v104, v106
    v_and_b32 v108, 0xffff0000, v108
    v_max_f32 v106, 0, v106
    v_xor_b32 v108, 0x80000000, v108
    v_cvt_pk_bf16_f32 v106, v106, v106
    v_and_b32 v106, 0xffff0000, v106
    v_add_f32 v106, 0x3727c5ac, v106
    v_cvt_pk_bf16_f32 v106, v106, v106
    v_and_b32 v106, 0xffff0000, v106
    v_sqrt_f32 v106, v106
    v_lshl_add_u32 v112, v2, 4, v112
    v_cvt_pk_bf16_f32 v106, v106, v106
    v_and_b32 v106, 0xffff0000, v106
    v_rcp_f32 v110, v106
    v_rcp_f32 v111, v106
    v_add_u32 v112, s43, v112
    v_dot2_f32_bf16 v80, v40, s5, v108
    v_dot2_f32_bf16 v81, v40, s6, v108
    v_dot2_f32_bf16 v82, v41, s5, v108
    v_dot2_f32_bf16 v83, v41, s6, v108
    v_dot2_f32_bf16 v84, v42, s5, v108
    v_dot2_f32_bf16 v85, v42, s6, v108
    v_dot2_f32_bf16 v86, v43, s5, v108
    v_dot2_f32_bf16 v87, v43, s6, v108
    s_nop 0
    v_pk_mul_f32 v[80:81], v[80:81], v[110:111]
    v_pk_mul_f32 v[82:83], v[82:83], v[110:111]
    v_pk_mul_f32 v[84:85], v[84:85], v[110:111]
    v_pk_mul_f32 v[86:87], v[86:87], v[110:111]
    v_cvt_pk_bf16_f32 v40, v80, v81
    v_cvt_pk_bf16_f32 v41, v82, v83
    v_cvt_pk_bf16_f32 v42, v84, v85
    v_cvt_pk_bf16_f32 v43, v86, v87
    v_dot2_f32_bf16 v88, v44, s5, v108
    v_dot2_f32_bf16 v89, v44, s6, v108
    v_dot2_f32_bf16 v90, v45, s5, v108
    v_dot2_f32_bf16 v91, v45, s6, v108
    v_dot2_f32_bf16 v92, v46, s5, v108
    v_dot2_f32_bf16 v93, v46, s6, v108
    v_dot2_f32_bf16 v94, v47, s5, v108
    v_dot2_f32_bf16 v95, v47, s6, v108
    ds_write_b128 v112, v[40:43] offset:0
    v_pk_mul_f32 v[88:89], v[88:89], v[110:111]
    v_pk_mul_f32 v[90:91], v[90:91], v[110:111]
    v_pk_mul_f32 v[92:93], v[92:93], v[110:111]
    v_pk_mul_f32 v[94:95], v[94:95], v[110:111]
    v_cvt_pk_bf16_f32 v44, v88, v89
    v_cvt_pk_bf16_f32 v45, v90, v91
    v_cvt_pk_bf16_f32 v46, v92, v93
    v_cvt_pk_bf16_f32 v47, v94, v95
    v_dot2_f32_bf16 v80, v48, s5, v108
    v_dot2_f32_bf16 v81, v48, s6, v108
    v_dot2_f32_bf16 v82, v49, s5, v108
    v_dot2_f32_bf16 v83, v49, s6, v108
    v_dot2_f32_bf16 v84, v50, s5, v108
    v_dot2_f32_bf16 v85, v50, s6, v108
    v_dot2_f32_bf16 v86, v51, s5, v108
    v_dot2_f32_bf16 v87, v51, s6, v108
    ds_write_b128 v112, v[44:47] offset:4224
    v_pk_mul_f32 v[80:81], v[80:81], v[110:111]
    v_pk_mul_f32 v[82:83], v[82:83], v[110:111]
    v_pk_mul_f32 v[84:85], v[84:85], v[110:111]
    v_pk_mul_f32 v[86:87], v[86:87], v[110:111]
    v_cvt_pk_bf16_f32 v48, v80, v81
    v_cvt_pk_bf16_f32 v49, v82, v83
    v_cvt_pk_bf16_f32 v50, v84, v85
    v_cvt_pk_bf16_f32 v51, v86, v87
    v_dot2_f32_bf16 v88, v52, s5, v108
    v_dot2_f32_bf16 v89, v52, s6, v108
    v_dot2_f32_bf16 v90, v53, s5, v108
    v_dot2_f32_bf16 v91, v53, s6, v108
    v_dot2_f32_bf16 v92, v54, s5, v108
    v_dot2_f32_bf16 v93, v54, s6, v108
    v_dot2_f32_bf16 v94, v55, s5, v108
    v_dot2_f32_bf16 v95, v55, s6, v108
    ds_write_b128 v112, v[48:51] offset:8448
    v_pk_mul_f32 v[88:89], v[88:89], v[110:111]
    v_pk_mul_f32 v[90:91], v[90:91], v[110:111]
    v_pk_mul_f32 v[92:93], v[92:93], v[110:111]
    v_pk_mul_f32 v[94:95], v[94:95], v[110:111]
    v_cvt_pk_bf16_f32 v52, v88, v89
    v_cvt_pk_bf16_f32 v53, v90, v91
    v_cvt_pk_bf16_f32 v54, v92, v93
    v_cvt_pk_bf16_f32 v55, v94, v95
    v_dot2_f32_bf16 v80, v56, s5, v108
    v_dot2_f32_bf16 v81, v56, s6, v108
    v_dot2_f32_bf16 v82, v57, s5, v108
    v_dot2_f32_bf16 v83, v57, s6, v108
    v_dot2_f32_bf16 v84, v58, s5, v108
    v_dot2_f32_bf16 v85, v58, s6, v108
    v_dot2_f32_bf16 v86, v59, s5, v108
    v_dot2_f32_bf16 v87, v59, s6, v108
    ds_write_b128 v112, v[52:55] offset:12672
    v_pk_mul_f32 v[80:81], v[80:81], v[110:111]
    v_pk_mul_f32 v[82:83], v[82:83], v[110:111]
    v_pk_mul_f32 v[84:85], v[84:85], v[110:111]
    v_pk_mul_f32 v[86:87], v[86:87], v[110:111]
    v_cvt_pk_bf16_f32 v56, v80, v81
    v_cvt_pk_bf16_f32 v57, v82, v83
    v_cvt_pk_bf16_f32 v58, v84, v85
    v_cvt_pk_bf16_f32 v59, v86, v87
    v_dot2_f32_bf16 v88, v60, s5, v108
    v_dot2_f32_bf16 v89, v60, s6, v108
    v_dot2_f32_bf16 v90, v61, s5, v108
    v_dot2_f32_bf16 v91, v61, s6, v108
    v_dot2_f32_bf16 v92, v62, s5, v108
    v_dot2_f32_bf16 v93, v62, s6, v108
    v_dot2_f32_bf16 v94, v63, s5, v108
    v_dot2_f32_bf16 v95, v63, s6, v108
    ds_write_b128 v112, v[56:59] offset:16896
    v_pk_mul_f32 v[88:89], v[88:89], v[110:111]
    v_pk_mul_f32 v[90:91], v[90:91], v[110:111]
    v_pk_mul_f32 v[92:93], v[92:93], v[110:111]
    v_pk_mul_f32 v[94:95], v[94:95], v[110:111]
    v_cvt_pk_bf16_f32 v60, v88, v89
    v_cvt_pk_bf16_f32 v61, v90, v91
    v_cvt_pk_bf16_f32 v62, v92, v93
    v_cvt_pk_bf16_f32 v63, v94, v95
    v_dot2_f32_bf16 v80, v64, s5, v108
    v_dot2_f32_bf16 v81, v64, s6, v108
    v_dot2_f32_bf16 v82, v65, s5, v108
    v_dot2_f32_bf16 v83, v65, s6, v108
    v_dot2_f32_bf16 v84, v66, s5, v108
    v_dot2_f32_bf16 v85, v66, s6, v108
    v_dot2_f32_bf16 v86, v67, s5, v108
    v_dot2_f32_bf16 v87, v67, s6, v108
    ds_write_b128 v112, v[60:63] offset:21120
    v_pk_mul_f32 v[80:81], v[80:81], v[110:111]
    v_pk_mul_f32 v[82:83], v[82:83], v[110:111]
    v_pk_mul_f32 v[84:85], v[84:85], v[110:111]
    v_pk_mul_f32 v[86:87], v[86:87], v[110:111]
    v_cvt_pk_bf16_f32 v64, v80, v81
    v_cvt_pk_bf16_f32 v65, v82, v83
    v_cvt_pk_bf16_f32 v66, v84, v85
    v_cvt_pk_bf16_f32 v67, v86, v87
    v_dot2_f32_bf16 v88, v68, s5, v108
    v_dot2_f32_bf16 v89, v68, s6, v108
    v_dot2_f32_bf16 v90, v69, s5, v108
    v_dot2_f32_bf16 v91, v69, s6, v108
    v_dot2_f32_bf16 v92, v70, s5, v108
    v_dot2_f32_bf16 v93, v70, s6, v108
    v_dot2_f32_bf16 v94, v71, s5, v108
    v_dot2_f32_bf16 v95, v71, s6, v108
    ds_write_b128 v112, v[64:67] offset:25344
    v_pk_mul_f32 v[88:89], v[88:89], v[110:111]
    v_pk_mul_f32 v[90:91], v[90:91], v[110:111]
    v_pk_mul_f32 v[92:93], v[92:93], v[110:111]
    v_pk_mul_f32 v[94:95], v[94:95], v[110:111]
    v_cvt_pk_bf16_f32 v68, v88, v89
    v_cvt_pk_bf16_f32 v69, v90, v91
    v_cvt_pk_bf16_f32 v70, v92, v93
    v_cvt_pk_bf16_f32 v71, v94, v95
    ds_write_b128 v112, v[68:71] offset:29568
    s_cmp_eq_u32 s3, 0
    s_cbranch_scc1 L_attn
    s_setprio 1
    s_waitcnt vmcnt(0) lgkmcnt(0)
    s_barrier
    ds_read_b128 a[0:3], v31 offset:0
    ds_read_b128 a[4:7], v31 offset:1056
    ds_read_b128 a[8:11], v31 offset:2112
    ds_read_b128 a[12:15], v31 offset:3168
    ds_read_b128 a[16:19], v31 offset:4224
    ds_read_b128 a[20:23], v31 offset:5280
    ds_read_b128 a[24:27], v31 offset:6336
    ds_read_b128 a[28:31], v31 offset:7392
    ds_read_b64_tr_b16 v[32:33], v12 offset:0
    ds_read_b64_tr_b16 v[34:35], v12 offset:512
    ds_read_b128 a[32:35], v31 offset:8448
    ds_read_b128 a[36:39], v31 offset:9504
    ds_read_b128 a[40:43], v31 offset:10560
    ds_read_b64_tr_b16 v[36:37], v12 offset:2048
    ds_read_b64_tr_b16 v[38:39], v12 offset:2560
    s_waitcnt lgkmcnt(12)
    ds_read_b128 a[44:47], v31 offset:11616
    ds_read_b128 a[48:51], v31 offset:12672
    ds_read_b128 a[52:55], v31 offset:13728
    s_waitcnt lgkmcnt(12)
    ds_read_b64_tr_b16 v[112:113], v12 offset:4096
    ds_read_b64_tr_b16 v[114:115], v12 offset:4608
    ds_read_b128 a[56:59], v31 offset:14784
    s_waitcnt lgkmcnt(12)
    ds_read_b128 a[60:63], v31 offset:15840
    ds_read_b128 a[64:67], v31 offset:16896
    ds_read_b64_tr_b16 v[116:117], v12 offset:6144
    s_waitcnt lgkmcnt(12)
    ds_read_b64_tr_b16 v[118:119], v12 offset:6656
    ds_read_b128 a[68:71], v31 offset:17952
    ds_read_b128 a[72:75], v31 offset:19008
    s_waitcnt lgkmcnt(12)
    ds_read_b128 a[76:79], v31 offset:20064
    ds_read_b64_tr_b16 v[120:121], v12 offset:8192
    ds_read_b64_tr_b16 v[122:123], v12 offset:8704
    s_waitcnt lgkmcnt(12)
    ds_read_b128 a[80:83], v31 offset:21120
    ds_read_b128 a[84:87], v31 offset:22176
    ds_read_b128 a[88:91], v31 offset:23232
    s_waitcnt lgkmcnt(12)
    ds_read_b64_tr_b16 v[124:125], v12 offset:10240
    ds_read_b64_tr_b16 v[126:127], v12 offset:10752
    ds_read_b128 a[92:95], v31 offset:24288
    s_waitcnt lgkmcnt(12)
    ds_read_b128 a[96:99], v31 offset:25344
    ds_read_b128 a[100:103], v31 offset:26400
    v_mfma_f32_32x32x16_bf16 v[40:55], v[32:35], a[0:3], 0
    ds_read_b64_tr_b16 v[32:33], v12 offset:12288
    s_waitcnt lgkmcnt(12)
    ds_read_b64_tr_b16 v[34:35], v12 offset:12800
    ds_read_b128 a[104:107], v31 offset:27456
    ds_read_b128 a[108:111], v31 offset:28512
    s_waitcnt lgkmcnt(12)
    ds_read_b128 v[96:99], v31 offset:29568
    v_mfma_f32_32x32x16_bf16 v[40:55], v[36:39], a[4:7], v[40:55]
    ds_read_b64_tr_b16 v[36:37], v12 offset:14336
    ds_read_b64_tr_b16 v[38:39], v12 offset:14848
    s_waitcnt lgkmcnt(12)
    ds_read_b128 v[100:103], v31 offset:30624
    ds_read_b128 v[104:107], v31 offset:31680
    ds_read_b128 v[108:111], v31 offset:32736
    v_mfma_f32_32x32x16_bf16 v[40:55], v[112:115], a[8:11], v[40:55]
    s_waitcnt lgkmcnt(12)
    ds_read_b64_tr_b16 v[112:113], v12 offset:16384
    ds_read_b64_tr_b16 v[114:115], v12 offset:16896
    ds_add_u32 v18, v19
    v_mfma_f32_32x32x16_bf16 v[40:55], v[116:119], a[12:15], v[40:55]
    s_waitcnt lgkmcnt(12)
    ds_read_b64_tr_b16 v[116:117], v12 offset:18432
    ds_read_b64_tr_b16 v[118:119], v12 offset:18944
    buffer_store_dwordx4 v[136:139], v21, s[28:31], s69 offen sc1
    buffer_store_dwordx4 v[136:139], v21, s[28:31], s65 offen sc1
    buffer_store_dword v136, v140, s[28:31], s0 offen sc1
    v_mfma_f32_32x32x16_bf16 v[40:55], v[120:123], a[16:19], v[40:55]
    ds_read_b64_tr_b16 v[120:121], v12 offset:20480
    s_waitcnt lgkmcnt(12)
    ds_read_b64_tr_b16 v[122:123], v12 offset:20992
    v_mul_u32_u24 v8, 2752, v2
    v_add_u32 v8, v8, v5
    v_add_u32 v9, 20992, v8
    v_mfma_f32_32x32x16_bf16 v[40:55], v[124:127], a[20:23], v[40:55]
    ds_read_b64_tr_b16 v[124:125], v12 offset:22528
    ds_read_b64_tr_b16 v[126:127], v12 offset:23040
    s_mul_i32 s53, s49, 88064
    s_lshl_b32 s43, s59, 7
    s_add_u32 s53, s53, s43
    s_waitcnt lgkmcnt(12)
    v_mfma_f32_32x32x16_bf16 v[40:55], v[32:35], a[24:27], v[40:55]
    ds_read_b64_tr_b16 v[32:33], v12 offset:24576
    ds_read_b64_tr_b16 v[34:35], v12 offset:25088
    s_mov_b32 s32, s22
    s_mov_b32 s33, s23
    s_mov_b32 s34, 2097152
    v_mfma_f32_32x32x16_bf16 v[40:55], v[36:39], a[28:31], v[40:55]
    ds_read_b64_tr_b16 v[36:37], v12 offset:26624
    s_waitcnt lgkmcnt(12)
    ds_read_b64_tr_b16 v[38:39], v12 offset:27136
    s_mov_b32 s35, 0x00020000
    s_mov_b32 s22, 1409024
    s_mov_b32 s23, 0x00020000
    s_waitcnt lgkmcnt(8)
    v_mfma_f32_32x32x16_bf16 v[40:55], v[112:115], a[32:35], v[40:55]
    ds_read_b64_tr_b16 v[112:113], v12 offset:28672
    ds_read_b64_tr_b16 v[114:115], v12 offset:29184
    ds_read_b32 v20, v0 offset:1024
    s_mov_b32 s26, 524288
    s_mov_b32 s27, 0x00020000
    v_lshl_add_u32 v10, v2, 10, v5
    v_mfma_f32_32x32x16_bf16 v[40:55], v[116:119], a[36:39], v[40:55]
    ds_read_b64_tr_b16 v[116:117], v12 offset:30720
    ds_read_b64_tr_b16 v[118:119], v12 offset:31232
    v_add_u32 v11, 7168, v10
    s_lshl_b32 s45, s42, 7
    s_lshl_b32 s54, s48, 14
    s_waitcnt lgkmcnt(9)
    v_mfma_f32_32x32x16_bf16 v[40:55], v[120:123], a[40:43], v[40:55]
    s_waitcnt lgkmcnt(2)
    v_cmp_gt_u32 vcc, 3, v20
    s_cbranch_vccnz L_chk1
L_chk1_x:
    ds_read_b64_tr_b16 v[120:121], v12 offset:32768
    ds_read_b64_tr_b16 v[122:123], v12 offset:33280
    ds_add_u32 v18, v19
    s_add_u32 s54, s54, s45
    s_lshl_b32 s55, s48, 17
    v_mfma_f32_32x32x16_bf16 v[40:55], v[124:127], a[44:47], v[40:55]
    ds_read_b64_tr_b16 v[124:125], v12 offset:34816
    ds_read_b64_tr_b16 v[126:127], v12 offset:35328
    s_add_u32 s55, s55, s45
    s_lshl_b32 s67, s41, 16
    s_add_u32 s67, s67, s45
    v_mfma_f32_32x32x16_bf16 v[40:55], v[32:35], a[48:51], v[40:55]
    ds_read_b64_tr_b16 v[32:33], v12 offset:36864
    ds_read_b64_tr_b16 v[34:35], v12 offset:37376
    s_and_b32 s60, s42, 3
    v_lshl_add_u32 v14, v26, 6, v14
    v_lshl_add_u32 v14, v27, 9, v14
    v_mfma_f32_32x32x16_bf16 v[40:55], v[36:39], a[52:55], v[40:55]
    ds_read_b64_tr_b16 v[36:37], v12 offset:38912
    ds_read_b64_tr_b16 v[38:39], v12 offset:39424
    v_add_u32 v14, s51, v14
    s_lshl_b32 s43, s50, 6
    v_xor_b32 v14, s43, v14
    s_waitcnt lgkmcnt(9)
    v_mfma_f32_32x32x16_bf16 v[40:55], v[112:115], a[56:59], v[40:55]
    ds_read_b64_tr_b16 v[112:113], v12 offset:40960
    ds_read_b64_tr_b16 v[114:115], v12 offset:41472
    v_xor_b32 v16, 64, v14
    v_add_u32 v15, 65536, v14
    v_add_u32 v17, 65536, v16
    v_mfma_f32_32x32x16_bf16 v[40:55], v[116:119], a[60:63], v[40:55]
    ds_read_b64_tr_b16 v[116:117], v12 offset:43008
    ds_read_b64_tr_b16 v[118:119], v12 offset:43520
    v_lshlrev_b32 v23, 7, v1
    v_lshlrev_b32 v25, 16, v24
    v_lshl_add_u32 v25, v27, 8, v25
    s_waitcnt lgkmcnt(8)
    v_mfma_f32_32x32x16_bf16 v[40:55], v[120:123], a[64:67], v[40:55]
    ds_read_b64_tr_b16 v[120:121], v12 offset:45056
    ds_read_b64_tr_b16 v[122:123], v12 offset:45568
    ds_read_b32 v20, v0 offset:1024
    v_and_b32 v4, 15, v1
    v_lshl_add_u32 v25, v4, 4, v25
    v_add_u32 v25, 4194304, v25
    v_mfma_f32_32x32x16_bf16 v[40:55], v[124:127], a[68:71], v[40:55]
    ds_read_b64_tr_b16 v[124:125], v12 offset:47104
    ds_read_b64_tr_b16 v[126:127], v12 offset:47616
    v_lshlrev_b32 v28, 10, v29
    v_lshl_add_u32 v28, v27, 3, v28
    s_waitcnt lgkmcnt(9)
    v_mfma_f32_32x32x16_bf16 v[40:55], v[32:35], a[72:75], v[40:55]
    s_waitcnt lgkmcnt(2)
    v_cmp_gt_u32 vcc, 4, v20
    s_cbranch_vccnz L_chk2
L_chk2_x:
    ds_read_b64_tr_b16 v[32:33], v12 offset:49152
    ds_read_b64_tr_b16 v[34:35], v12 offset:49664
    ds_add_u32 v18, v19
    v_lshl_add_u32 v30, v27, 3, v28
    s_lshl_b32 s43, s48, 12
    v_add_u32 v29, s43, v21
    v_mfma_f32_32x32x16_bf16 v[40:55], v[36:39], a[76:79], v[40:55]
    ds_read_b64_tr_b16 v[36:37], v12 offset:51200
    ds_read_b64_tr_b16 v[38:39], v12 offset:51712
    s_and_b32 s52, s2, 7
    s_lshl_b32 s52, s52, 2
    s_bfe_u32 s43, s2, 0x20003
    v_mfma_f32_32x32x16_bf16 v[40:55], v[112:115], a[80:83], v[40:55]
    ds_read_b64_tr_b16 v[112:113], v12 offset:53248
    ds_read_b64_tr_b16 v[114:115], v12 offset:53760
    s_add_u32 s52, s52, s43
    s_lshl_b32 s52, s52, 16
    s_lshl_b32 s43, s50, 15
    v_mfma_f32_32x32x16_bf16 v[40:55], v[116:119], a[84:87], v[40:55]
    ds_read_b64_tr_b16 v[116:117], v12 offset:55296
    ds_read_b64_tr_b16 v[118:119], v12 offset:55808
    s_add_u32 s52, s52, s43
    s_lshl_b32 s43, s49, 21
    s_add_u32 s52, s52, s43
    s_waitcnt lgkmcnt(9)
    v_mfma_f32_32x32x16_bf16 v[40:55], v[120:123], a[88:91], v[40:55]
    ds_read_b64_tr_b16 v[120:121], v12 offset:57344
    ds_read_b64_tr_b16 v[122:123], v12 offset:57856
    s_add_u32 s52, s52, 2097152
    s_mul_i32 s1, s48, 10560
    s_lshl_b32 s43, s49, 15
    v_mfma_f32_32x32x16_bf16 v[40:55], v[124:127], a[92:95], v[40:55]
    ds_read_b64_tr_b16 v[124:125], v12 offset:59392
    ds_read_b64_tr_b16 v[126:127], v12 offset:59904
    s_add_u32 s67, s67, s43
    s_lshl_b32 s43, s50, 6
    s_add_u32 s67, s67, s43
    s_waitcnt lgkmcnt(8)
    v_mfma_f32_32x32x16_bf16 v[40:55], v[32:35], a[96:99], v[40:55]
    ds_read_b64_tr_b16 v[32:33], v12 offset:61440
    ds_read_b64_tr_b16 v[34:35], v12 offset:61952
    ds_read_b32 v20, v0 offset:1024
    v_and_b32 v24, 0x33, v1
    v_lshrrev_b32 v4, 1, v1
    v_and_b32 v4, 4, v4
    v_mfma_f32_32x32x16_bf16 v[40:55], v[36:39], a[100:103], v[40:55]
    ds_read_b64_tr_b16 v[36:37], v12 offset:63488
    ds_read_b64_tr_b16 v[38:39], v12 offset:64000
    v_lshlrev_b32 v27, 1, v1
    v_and_b32 v27, 8, v27
    s_waitcnt lgkmcnt(9)
    v_mfma_f32_32x32x16_bf16 v[40:55], v[112:115], a[104:107], v[40:55]
    s_waitcnt lgkmcnt(2)
    v_cmp_gt_u32 vcc, 5, v20
    s_cbranch_vccnz L_chk3
L_chk3_x:
    ds_read_b64_tr_b16 v[112:113], v13 offset:0
    ds_read_b64_tr_b16 v[114:115], v13 offset:512
    ds_add_u32 v18, v19
    v_mfma_f32_32x32x16_bf16 v[40:55], v[116:119], a[108:111], v[40:55]
    ds_read_b64_tr_b16 v[116:117], v13 offset:2048
    ds_read_b64_tr_b16 v[118:119], v13 offset:2560
    v_or3_b32 v24, v24, v4, v27
    v_lshlrev_b32 v24, 4, v24
    v_add_u32 v24, 2097152, v24
    v_mfma_f32_32x32x16_bf16 v[40:55], v[120:123], v[96:99], v[40:55]
    ds_read_b64_tr_b16 v[120:121], v13 offset:4096
    ds_read_b64_tr_b16 v[122:123], v13 offset:4608
    s_mul_i32 s43, s49, 88064
    v_add_u32 v6, s43, v21
    s_sub_u32 s43, 88064, s43
    v_mfma_f32_32x32x16_bf16 v[40:55], v[124:127], v[100:103], v[40:55]
    ds_read_b64_tr_b16 v[124:125], v13 offset:6144
    ds_read_b64_tr_b16 v[126:127], v13 offset:6656
    v_add_u32 v26, s43, v21
    s_lshl_b32 s43, s49, 15
    v_add_u32 v7, s43, v21
    s_waitcnt lgkmcnt(9)
    v_mfma_f32_32x32x16_bf16 v[40:55], v[32:35], v[104:107], v[40:55]
    ds_read_b64_tr_b16 v[32:33], v13 offset:8192
    ds_read_b64_tr_b16 v[34:35], v13 offset:8704
    v_xor_b32 v27, 32768, v7
    v_lshlrev_b32 v31, 10, v1
    v_mov_b32 v4, 0
    v_mfma_f32_32x32x16_bf16 v[40:55], v[36:39], v[108:111], v[40:55]
    ds_read_b64_tr_b16 v[36:37], v13 offset:10240
    ds_read_b64_tr_b16 v[38:39], v13 offset:10752
    v_mov_b32 v2, 0xc0135761
    v_mov_b32 v3, 0xc0135761
    s_lshl_b32 s45, s41, 1
    s_waitcnt lgkmcnt(8)
    v_mfma_f32_32x32x16_bf16 v[56:71], a[0:3], v[112:115], 0
    ds_read_b64_tr_b16 v[112:113], v13 offset:12288
    ds_read_b64_tr_b16 v[114:115], v13 offset:12800
    ds_read_b32 v20, v0 offset:1024
    s_add_u32 s45, s45, s49
    s_mul_i32 s58, s45, 88064
    s_lshl_b32 s44, s42, 1
    v_mfma_f32_32x32x16_bf16 v[56:71], a[4:7], v[116:119], v[56:71]
    ds_read_b64_tr_b16 v[116:117], v13 offset:14336
    ds_read_b64_tr_b16 v[118:119], v13 offset:14848
    s_add_u32 s44, s44, s50
    s_lshl_b32 s57, s44, 13
    s_waitcnt lgkmcnt(9)
    v_mfma_f32_32x32x16_bf16 v[56:71], a[8:11], v[120:123], v[56:71]
    s_waitcnt lgkmcnt(2)
    v_cmp_gt_u32 vcc, 6, v20
    s_cbranch_vccnz L_chk4
L_chk4_x:
    ds_read_b64_tr_b16 v[120:121], v13 offset:16384
    ds_read_b64_tr_b16 v[122:123], v13 offset:16896
    ds_add_u32 v18, v19
    v_mfma_f32_32x32x16_bf16 v[56:71], a[12:15], v[124:127], v[56:71]
    ds_read_b64_tr_b16 v[124:125], v13 offset:18432
    ds_read_b64_tr_b16 v[126:127], v13 offset:18944
    s_lshl_b32 s43, s45, 7
    s_add_u32 s57, s57, s43
    s_add_u32 s57, s57, 25165824
    v_mfma_f32_32x32x16_bf16 v[56:71], a[16:19], v[32:35], v[56:71]
    ds_read_b64_tr_b16 v[32:33], v13 offset:20480
    ds_read_b64_tr_b16 v[34:35], v13 offset:20992
    s_lshl_b32 s43, s59, 12
    s_lshl_b32 s44, s50, 11
    s_add_u32 s58, s58, s43
    v_mfma_f32_32x32x16_bf16 v[56:71], a[20:23], v[36:39], v[56:71]
    ds_read_b64_tr_b16 v[36:37], v13 offset:22528
    ds_read_b64_tr_b16 v[38:39], v13 offset:23040
    s_add_u32 s58, s58, s44
    s_add_u32 s58, s58, 10485760
    s_lshl_b32 s66, s41, 14
    s_waitcnt lgkmcnt(9)
    v_mfma_f32_32x32x16_bf16 v[56:71], a[24:27], v[112:115], v[56:71]
    ds_read_b64_tr_b16 v[112:113], v13 offset:24576
    ds_read_b64_tr_b16 v[114:115], v13 offset:25088
    s_add_u32 s66, s66, 25296896
    s_lshl_b32 s43, s42, 9
    s_lshl_b32 s44, s48, 7
    v_mfma_f32_32x32x16_bf16 v[56:71], a[28:31], v[116:119], v[56:71]
    ds_read_b64_tr_b16 v[116:117], v13 offset:26624
    ds_read_b64_tr_b16 v[118:119], v13 offset:27136
    s_add_u32 s61, s43, s44
    s_add_u32 s61, s61, s66
    s_mul_i32 s68, s41, 176128
    s_waitcnt lgkmcnt(8)
    v_mfma_f32_32x32x16_bf16 v[56:71], a[32:35], v[120:123], v[56:71]
    ds_read_b64_tr_b16 v[120:121], v13 offset:28672
    ds_read_b64_tr_b16 v[122:123], v13 offset:29184
    ds_read_b32 v20, v0 offset:1024
    s_lshl_b32 s43, s48, 10
    s_add_u32 s68, s68, s43
    s_add_u32 s68, s68, 10485760
    v_mfma_f32_32x32x16_bf16 v[56:71], a[36:39], v[124:127], v[56:71]
    ds_read_b64_tr_b16 v[124:125], v13 offset:30720
    ds_read_b64_tr_b16 v[126:127], v13 offset:31232
    s_mov_b32 s62, 0x3eb8aa3b
    s_mov_b32 s63, 0x3eb8aa3b
    s_waitcnt lgkmcnt(9)
    v_mfma_f32_32x32x16_bf16 v[56:71], a[40:43], v[32:35], v[56:71]
    s_waitcnt lgkmcnt(2)
    v_cmp_gt_u32 vcc, 7, v20
    s_cbranch_vccnz L_chk5
L_chk5_x:
    ds_read_b64_tr_b16 v[32:33], v13 offset:32768
    ds_read_b64_tr_b16 v[34:35], v13 offset:33280
    ds_add_u32 v18, v19
    v_mfma_f32_32x32x16_bf16 v[56:71], a[44:47], v[36:39], v[56:71]
    ds_read_b64_tr_b16 v[36:37], v13 offset:34816
    ds_read_b64_tr_b16 v[38:39], v13 offset:35328
    v_cvt_pk_bf16_f32 v72, v40, v41
    v_cvt_pk_bf16_f32 v73, v42, v43
    v_mfma_f32_32x32x16_bf16 v[56:71], a[48:51], v[112:115], v[56:71]
    ds_read_b64_tr_b16 v[112:113], v13 offset:36864
    ds_read_b64_tr_b16 v[114:115], v13 offset:37376
    v_cvt_pk_bf16_f32 v74, v44, v45
    v_cvt_pk_bf16_f32 v75, v46, v47
    v_mfma_f32_32x32x16_bf16 v[56:71], a[52:55], v[116:119], v[56:71]
    ds_read_b64_tr_b16 v[116:117], v13 offset:38912
    ds_read_b64_tr_b16 v[118:119], v13 offset:39424
    v_cvt_pk_bf16_f32 v76, v48, v49
    v_cvt_pk_bf16_f32 v77, v50, v51
    s_waitcnt lgkmcnt(9)
    v_mfma_f32_32x32x16_bf16 v[56:71], a[56:59], v[120:123], v[56:71]
    ds_read_b64_tr_b16 v[120:121], v13 offset:40960
    ds_read_b64_tr_b16 v[122:123], v13 offset:41472
    v_cvt_pk_bf16_f32 v78, v52, v53
    v_cvt_pk_bf16_f32 v79, v54, v55
    v_mfma_f32_32x32x16_bf16 v[56:71], a[60:63], v[124:127], v[56:71]
    ds_read_b64_tr_b16 v[124:125], v13 offset:43008
    ds_read_b64_tr_b16 v[126:127], v13 offset:43520
    buffer_store_dwordx4 v[72:75], v24, s[28:31], s69 offen sc1
    buffer_store_dwordx4 v[76:79], v24, s[28:31], s65 offen sc1
    s_waitcnt lgkmcnt(8)
    v_mfma_f32_32x32x16_bf16 v[56:71], a[64:67], v[32:35], v[56:71]
    ds_read_b64_tr_b16 v[32:33], v13 offset:45056
    ds_read_b64_tr_b16 v[34:35], v13 offset:45568
    ds_read_b32 v20, v0 offset:1024
    buffer_load_dword v22, v4, s[36:39], 0 offen sc1
    v_mfma_f32_32x32x16_bf16 v[56:71], a[68:71], v[36:39], v[56:71]
    ds_read_b64_tr_b16 v[36:37], v13 offset:47104
    ds_read_b64_tr_b16 v[38:39], v13 offset:47616
    s_waitcnt lgkmcnt(9)
    v_mfma_f32_32x32x16_bf16 v[56:71], a[72:75], v[112:115], v[56:71]
    s_waitcnt lgkmcnt(2)
    v_cmp_gt_u32 vcc, 8, v20
    s_cbranch_vccnz L_chk6
L_chk6_x:
    ds_read_b64_tr_b16 v[112:113], v13 offset:49152
    ds_read_b64_tr_b16 v[114:115], v13 offset:49664
    ds_add_u32 v18, v19
    v_mfma_f32_32x32x16_bf16 v[56:71], a[76:79], v[116:119], v[56:71]
    ds_read_b64_tr_b16 v[116:117], v13 offset:51200
    ds_read_b64_tr_b16 v[118:119], v13 offset:51712
    v_mfma_f32_32x32x16_bf16 v[56:71], a[80:83], v[120:123], v[56:71]
    ds_read_b64_tr_b16 v[120:121], v13 offset:53248
    ds_read_b64_tr_b16 v[122:123], v13 offset:53760
    v_mfma_f32_32x32x16_bf16 v[56:71], a[84:87], v[124:127], v[56:71]
    ds_read_b64_tr_b16 v[124:125], v13 offset:55296
    ds_read_b64_tr_b16 v[126:127], v13 offset:55808
    s_waitcnt lgkmcnt(9)
    v_mfma_f32_32x32x16_bf16 v[56:71], a[88:91], v[32:35], v[56:71]
    ds_read_b64_tr_b16 v[32:33], v13 offset:57344
    ds_read_b64_tr_b16 v[34:35], v13 offset:57856
    v_mfma_f32_32x32x16_bf16 v[56:71], a[92:95], v[36:39], v[56:71]
    ds_read_b64_tr_b16 v[36:37], v13 offset:59392
    ds_read_b64_tr_b16 v[38:39], v13 offset:59904
    s_waitcnt lgkmcnt(8)
    v_mfma_f32_32x32x16_bf16 v[56:71], a[96:99], v[112:115], v[56:71]
    ds_read_b64_tr_b16 v[112:113], v13 offset:61440
    ds_read_b64_tr_b16 v[114:115], v13 offset:61952
    ds_read_b32 v20, v0 offset:1024
    v_mfma_f32_32x32x16_bf16 v[56:71], a[100:103], v[116:119], v[56:71]
    ds_read_b64_tr_b16 v[116:117], v13 offset:63488
    ds_read_b64_tr_b16 v[118:119], v13 offset:64000
    s_waitcnt lgkmcnt(9)
    v_mfma_f32_32x32x16_bf16 v[56:71], a[104:107], v[120:123], v[56:71]
    s_waitcnt lgkmcnt(2)
    v_cmp_gt_u32 vcc, 9, v20
    s_cbranch_vccnz L_chk7
L_chk7_x:
    ds_read_b64_tr_b16 v[120:121], v12 offset:0
    ds_read_b64_tr_b16 v[122:123], v12 offset:512
    ds_add_u32 v18, v19
    v_mfma_f32_32x32x16_bf16 v[56:71], a[108:111], v[124:127], v[56:71]
    ds_read_b64_tr_b16 v[124:125], v12 offset:2048
    ds_read_b64_tr_b16 v[126:127], v12 offset:2560
    v_mfma_f32_32x32x16_bf16 v[56:71], v[96:99], v[32:35], v[56:71]
    ds_read_b64_tr_b16 v[32:33], v12 offset:4096
    ds_read_b64_tr_b16 v[34:35], v12 offset:4608
    v_mfma_f32_32x32x16_bf16 v[56:71], v[100:103], v[36:39], v[56:71]
    ds_read_b64_tr_b16 v[36:37], v12 offset:6144
    ds_read_b64_tr_b16 v[38:39], v12 offset:6656
    s_waitcnt lgkmcnt(9)
    v_mfma_f32_32x32x16_bf16 v[56:71], v[104:107], v[112:115], v[56:71]
    ds_read_b64_tr_b16 v[112:113], v12 offset:8192
    ds_read_b64_tr_b16 v[114:115], v12 offset:8704
    v_mfma_f32_32x32x16_bf16 v[56:71], v[108:111], v[116:119], v[56:71]
    ds_read_b64_tr_b16 v[116:117], v12 offset:10240
    ds_read_b64_tr_b16 v[118:119], v12 offset:10752
    s_waitcnt lgkmcnt(8)
    v_mfma_f32_32x32x16_bf16 v[40:55], v[120:123], a[0:3], 0
    ds_read_b64_tr_b16 v[120:121], v12 offset:12288
    ds_read_b64_tr_b16 v[122:123], v12 offset:12800
    ds_read_b32 v20, v0 offset:1024
    v_mfma_f32_32x32x16_bf16 v[40:55], v[124:127], a[4:7], v[40:55]
    ds_read_b64_tr_b16 v[124:125], v12 offset:14336
    ds_read_b64_tr_b16 v[126:127], v12 offset:14848
    s_waitcnt lgkmcnt(9)
    v_mfma_f32_32x32x16_bf16 v[40:55], v[32:35], a[8:11], v[40:55]
    s_waitcnt lgkmcnt(2)
    v_cmp_gt_u32 vcc, 10, v20
    s_cbranch_vccnz L_chk8
L_chk8_x:
    ds_read_b64_tr_b16 v[32:33], v12 offset:16384
    ds_read_b64_tr_b16 v[34:35], v12 offset:16896
    ds_add_u32 v18, v19
    v_mfma_f32_32x32x16_bf16 v[40:55], v[36:39], a[12:15], v[40:55]
    ds_read_b64_tr_b16 v[36:37], v12 offset:18432
    ds_read_b64_tr_b16 v[38:39], v12 offset:18944
    v_cvt_pk_bf16_f32 v80, v56, v57
    v_cvt_pk_bf16_f32 v81, v58, v59
    v_mfma_f32_32x32x16_bf16 v[40:55], v[112:115], a[16:19], v[40:55]
    ds_read_b64_tr_b16 v[112:113], v12 offset:20480
    ds_read_b64_tr_b16 v[114:115], v12 offset:20992
    v_cvt_pk_bf16_f32 v82, v60, v61
    v_cvt_pk_bf16_f32 v83, v62, v63
    v_mfma_f32_32x32x16_bf16 v[40:55], v[116:119], a[20:23], v[40:55]
    ds_read_b64_tr_b16 v[116:117], v12 offset:22528
    ds_read_b64_tr_b16 v[118:119], v12 offset:23040
    v_cvt_pk_bf16_f32 v84, v64, v65
    v_cvt_pk_bf16_f32 v85, v66, v67
    s_waitcnt lgkmcnt(9)
    v_mfma_f32_32x32x16_bf16 v[40:55], v[120:123], a[24:27], v[40:55]
    ds_read_b64_tr_b16 v[120:121], v12 offset:24576
    ds_read_b64_tr_b16 v[122:123], v12 offset:25088
    v_cvt_pk_bf16_f32 v86, v68, v69
    v_cvt_pk_bf16_f32 v87, v70, v71
    v_mfma_f32_32x32x16_bf16 v[40:55], v[124:127], a[28:31], v[40:55]
    ds_read_b64_tr_b16 v[124:125], v12 offset:26624
    ds_read_b64_tr_b16 v[126:127], v12 offset:27136
    buffer_store_dwordx4 v[80:83], v25, s[28:31], s69 offen sc1
    buffer_store_dwordx4 v[84:87], v25, s[28:31], s69 offen offset:512 sc1
    s_waitcnt lgkmcnt(8)
    v_mfma_f32_32x32x16_bf16 v[40:55], v[32:35], a[32:35], v[40:55]
    ds_read_b64_tr_b16 v[32:33], v12 offset:28672
    ds_read_b64_tr_b16 v[34:35], v12 offset:29184
    ds_read_b32 v20, v0 offset:1024
    v_mfma_f32_32x32x16_bf16 v[40:55], v[36:39], a[36:39], v[40:55]
    ds_read_b64_tr_b16 v[36:37], v12 offset:30720
    ds_read_b64_tr_b16 v[38:39], v12 offset:31232
    s_waitcnt lgkmcnt(9)
    v_mfma_f32_32x32x16_bf16 v[40:55], v[112:115], a[40:43], v[40:55]
    s_waitcnt lgkmcnt(2)
    v_cmp_gt_u32 vcc, 11, v20
    s_cbranch_vccnz L_chk9
L_chk9_x:
    ds_read_b64_tr_b16 v[112:113], v12 offset:32768
    ds_read_b64_tr_b16 v[114:115], v12 offset:33280
    ds_add_u32 v18, v19
    v_mfma_f32_32x32x16_bf16 v[40:55], v[116:119], a[44:47], v[40:55]
    ds_read_b64_tr_b16 v[116:117], v12 offset:34816
    ds_read_b64_tr_b16 v[118:119], v12 offset:35328
    v_mfma_f32_32x32x16_bf16 v[40:55], v[120:123], a[48:51], v[40:55]
    ds_read_b64_tr_b16 v[120:121], v12 offset:36864
    ds_read_b64_tr_b16 v[122:123], v12 offset:37376
    v_mfma_f32_32x32x16_bf16 v[40:55], v[124:127], a[52:55], v[40:55]
    ds_read_b64_tr_b16 v[124:125], v12 offset:38912
    ds_read_b64_tr_b16 v[126:127], v12 offset:39424
    s_waitcnt lgkmcnt(9)
    v_mfma_f32_32x32x16_bf16 v[40:55], v[32:35], a[56:59], v[40:55]
    ds_read_b64_tr_b16 v[32:33], v12 offset:40960
    ds_read_b64_tr_b16 v[34:35], v12 offset:41472
    v_mfma_f32_32x32x16_bf16 v[40:55], v[36:39], a[60:63], v[40:55]
    ds_read_b64_tr_b16 v[36:37], v12 offset:43008
    ds_read_b64_tr_b16 v[38:39], v12 offset:43520
    s_waitcnt lgkmcnt(8)
    v_mfma_f32_32x32x16_bf16 v[40:55], v[112:115], a[64:67], v[40:55]
    ds_read_b64_tr_b16 v[112:113], v12 offset:45056
    ds_read_b64_tr_b16 v[114:115], v12 offset:45568
    ds_read_b32 v20, v0 offset:1024
    v_mfma_f32_32x32x16_bf16 v[40:55], v[116:119], a[68:71], v[40:55]
    ds_read_b64_tr_b16 v[116:117], v12 offset:47104
    ds_read_b64_tr_b16 v[118:119], v12 offset:47616
    s_waitcnt lgkmcnt(9)
    v_mfma_f32_32x32x16_bf16 v[40:55], v[120:123], a[72:75], v[40:55]
    s_waitcnt lgkmcnt(2)
    v_cmp_gt_u32 vcc, 12, v20
    s_cbranch_vccnz L_chk10
L_chk10_x:
    ds_read_b64_tr_b16 v[120:121], v12 offset:49152
    ds_read_b64_tr_b16 v[122:123], v12 offset:49664
    ds_add_u32 v18, v19
    v_mfma_f32_32x32x16_bf16 v[40:55], v[124:127], a[76:79], v[40:55]
    ds_read_b64_tr_b16 v[124:125], v12 offset:51200
    ds_read_b64_tr_b16 v[126:127], v12 offset:51712
    v_mfma_f32_32x32x16_bf16 v[40:55], v[32:35], a[80:83], v[40:55]
    ds_read_b64_tr_b16 v[32:33], v12 offset:53248
    ds_read_b64_tr_b16 v[34:35], v12 offset:53760
    v_mfma_f32_32x32x16_bf16 v[40:55], v[36:39], a[84:87], v[40:55]
    ds_read_b64_tr_b16 v[36:37], v12 offset:55296
    ds_read_b64_tr_b16 v[38:39], v12 offset:55808
    s_waitcnt lgkmcnt(9)
    v_mfma_f32_32x32x16_bf16 v[40:55], v[112:115], a[88:91], v[40:55]
    ds_read_b64_tr_b16 v[112:113], v12 offset:57344
    ds_read_b64_tr_b16 v[114:115], v12 offset:57856
    v_mfma_f32_32x32x16_bf16 v[40:55], v[116:119], a[92:95], v[40:55]
    ds_read_b64_tr_b16 v[116:117], v12 offset:59392
    ds_read_b64_tr_b16 v[118:119], v12 offset:59904
    s_waitcnt lgkmcnt(8)
    v_mfma_f32_32x32x16_bf16 v[40:55], v[120:123], a[96:99], v[40:55]
    ds_read_b64_tr_b16 v[120:121], v12 offset:61440
    ds_read_b64_tr_b16 v[122:123], v12 offset:61952
    v_mfma_f32_32x32x16_bf16 v[40:55], v[124:127], a[100:103], v[40:55]
    ds_read_b64_tr_b16 v[124:125], v12 offset:63488
    ds_read_b64_tr_b16 v[126:127], v12 offset:64000
    s_waitcnt lgkmcnt(8)
    v_mfma_f32_32x32x16_bf16 v[40:55], v[32:35], a[104:107], v[40:55]
    v_mfma_f32_32x32x16_bf16 v[40:55], v[36:39], a[108:111], v[40:55]
    s_waitcnt lgkmcnt(4)
    v_mfma_f32_32x32x16_bf16 v[40:55], v[112:115], v[96:99], v[40:55]
    v_mfma_f32_32x32x16_bf16 v[40:55], v[116:119], v[100:103], v[40:55]
    s_waitcnt lgkmcnt(0)
    v_mfma_f32_32x32x16_bf16 v[40:55], v[120:123], v[104:107], v[40:55]
    v_mfma_f32_32x32x16_bf16 v[40:55], v[124:127], v[108:111], v[40:55]
    s_waitcnt vmcnt(2)
    v_readfirstlane_b32 s46, v22
    s_cmp_lg_u32 s46, 0
    s_cbranch_scc1 L_gtag_x
    v_mov_b32 v4, 0
L_gtag:
    buffer_load_dword v22, v4, s[36:39], 0 offen sc1
    s_waitcnt vmcnt(0)
    v_readfirstlane_b32 s46, v22
    s_sub_u32 s47, s47, 1
    s_cmp_lt_i32 s47, 0
    s_cbranch_scc1 L_gtag_x
    s_cmp_eq_u32 s46, 0
    s_cbranch_scc1 L_gtag
L_gtag_x:
    v_mov_b32 v22, s46
    s_waitcnt vmcnt(0)
    s_mov_b64 exec, 1
    buffer_store_dword v22, v4, s[28:31], s57 offen sc1
    s_mov_b64 exec, -1
    s_nop 3
    v_pk_mul_f32 v[40:41], v[40:41], s[62:63]
    v_pk_mul_f32 v[42:43], v[42:43], s[62:63]
    v_pk_mul_f32 v[44:45], v[44:45], s[62:63]
    v_pk_mul_f32 v[46:47], v[46:47], s[62:63]
    v_pk_mul_f32 v[48:49], v[48:49], s[62:63]
    v_pk_mul_f32 v[50:51], v[50:51], s[62:63]
    v_pk_mul_f32 v[52:53], v[52:53], s[62:63]
    v_pk_mul_f32 v[54:55], v[54:55], s[62:63]
    v_cvt_pk_bf16_f32 v88, v40, v41
    v_cvt_pk_bf16_f32 v89, v42, v43
    v_cvt_pk_bf16_f32 v90, v44, v45
    v_cvt_pk_bf16_f32 v91, v46, v47
    v_cvt_pk_bf16_f32 v92, v48, v49
    v_cvt_pk_bf16_f32 v93, v50, v51
    v_cvt_pk_bf16_f32 v94, v52, v53
    v_cvt_pk_bf16_f32 v95, v54, v55
    v_min_u32 v88, -2, v88
    v_min_u32 v89, -2, v89
    v_min_u32 v90, -2, v90
    v_min_u32 v91, -2, v91
    v_min_u32 v92, -2, v92
    v_min_u32 v93, -2, v93
    v_min_u32 v94, -2, v94
    v_min_u32 v95, -2, v95
    s_add_u32 s43, s69, 65536
    buffer_store_dwordx4 v[88:91], v21, s[28:31], s69 offen sc1
    buffer_store_dwordx4 v[92:95], v21, s[28:31], s43 offen sc1
    v_mfma_f32_32x32x16_bf16 v[56:71], v[72:75], v[88:91], 0
    v_mfma_f32_32x32x16_bf16 v[40:55], v[76:79], v[92:95], 0
    s_mov_b32 s43, 0xc2c80000
    s_nop 9
    v_max3_f32 v141, v56, v57, v71
    v_max3_f32 v141, v58, v59, v141
    v_max3_f32 v141, v60, v61, v141
    v_max3_f32 v141, v62, v63, v141
    v_max3_f32 v141, v64, v65, v141
    v_max3_f32 v141, v66, v67, v141
    v_max3_f32 v141, v68, v69, v141
    v_max3_f32 v141, v70, v71, v141
    v_max3_f32 v142, v40, v41, v55
    v_max3_f32 v142, v42, v43, v142
    v_max3_f32 v142, v44, v45, v142
    v_max3_f32 v142, v46, v47, v142
    v_max3_f32 v142, v48, v49, v142
    v_max3_f32 v142, v50, v51, v142
    v_max3_f32 v142, v52, v53, v142
    v_max3_f32 v142, v54, v55, v142
    s_nop 1
    v_permlane32_swap_b32 v141, v142
    v_max_f32 v141, v141, v142
    v_sub_f32 v141, s43, v141
    v_min_u32 v141, -2, v141
    buffer_store_dword v141, v140, s[28:31], s0 offen sc1
    s_mov_b32 s62, 0xbdd2d3e8
    s_mov_b32 s63, 0xbdd2d3e8
    ds_add_u32 v18, v19
    ds_read_b32 v20, v0 offset:1024
    s_waitcnt lgkmcnt(0)
    v_cmp_gt_u32 vcc, 13, v20
    s_cbranch_vccnz L_chk11
L_chk11_x:
    s_mov_b32 s56, 12
    s_setprio 0
    s_cmp_lg_u32 s60, 3
    s_cbranch_scc1 L_ffn
    ds_read_b32 v20, v0 offset:1024
    s_waitcnt lgkmcnt(0)
    s_setprio 3
    v_cmp_gt_u32 vcc, 14, v20
    s_setprio 0
    s_cbranch_vccnz L_chk12
L_chk12_x:
    ds_read_b32 v20, v0 offset:0
    s_waitcnt lgkmcnt(0)
    s_setprio 3
    v_cmp_gt_u32 vcc, 12, v20
    s_setprio 0
    s_cbranch_vccnz L_chk13
L_chk13_x:
    s_add_u32 m0, s1, 5280
    s_add_u32 s43, s52, 5120
    buffer_load_dwordx4 v21, s[28:31], s43 offen sc1 lds
    s_add_u32 m0, s1, 6336
    s_add_u32 s43, s52, 6144
    buffer_load_dwordx4 v21, s[28:31], s43 offen sc1 lds
    s_add_u32 m0, s1, 7392
    s_add_u32 s43, s52, 7168
    buffer_load_dwordx4 v21, s[28:31], s43 offen sc1 lds
    s_add_u32 m0, s1, 8448
    s_add_u32 s43, s52, 8192
    buffer_load_dwordx4 v21, s[28:31], s43 offen sc1 lds
    s_add_u32 m0, s1, 9504
    s_add_u32 s43, s52, 9216
    buffer_load_dwordx4 v21, s[28:31], s43 offen sc1 lds
    s_waitcnt vmcnt(4)
    ds_add_u32 v18, v19 offset:512
    s_waitcnt vmcnt(3)
    ds_add_u32 v18, v19 offset:512
    s_waitcnt vmcnt(2)
    ds_add_u32 v18, v19 offset:512
    s_waitcnt vmcnt(1)
    ds_add_u32 v18, v19 offset:512
    s_waitcnt vmcnt(0)
    ds_add_u32 v18, v19 offset:512
    s_add_u32 m0, s51, 98304
    s_add_u32 s64, s53, 128
    buffer_load_dwordx4 v8, s[16:19], s64 offen lds
    s_add_u32 m0, s51, 98304
    s_nop 0
    buffer_load_dwordx4 v9, s[16:19], s64 offen offset:1024 lds
    s_add_u32 m0, s51, 98304
    s_add_u32 s64, s53, 42112
    buffer_load_dwordx4 v8, s[16:19], s64 offen offset:2048 lds
    s_add_u32 m0, s51, 98304
    s_nop 0
    buffer_load_dwordx4 v9, s[16:19], s64 offen offset:3072 lds
    s_add_u32 m0, s51, 114688
    s_add_u32 s64, s53, 176256
    buffer_load_dwordx4 v8, s[16:19], s64 offen lds
    s_add_u32 m0, s51, 114688
    s_nop 0
    buffer_load_dwordx4 v9, s[16:19], s64 offen offset:1024 lds
    s_add_u32 m0, s51, 114688
    s_add_u32 s64, s53, 218240
    buffer_load_dwordx4 v8, s[16:19], s64 offen offset:2048 lds
    s_add_u32 m0, s51, 114688
    s_nop 0
    buffer_load_dwordx4 v9, s[16:19], s64 offen offset:3072 lds
    s_add_u32 m0, s51, 32768
    s_add_u32 s64, s53, 352384
    buffer_load_dwordx4 v8, s[16:19], s64 offen lds
    s_add_u32 m0, s51, 32768
    s_nop 0
    buffer_load_dwordx4 v9, s[16:19], s64 offen offset:1024 lds
    s_add_u32 m0, s51, 32768
    s_add_u32 s64, s53, 394368
    buffer_load_dwordx4 v8, s[16:19], s64 offen offset:2048 lds
    s_add_u32 m0, s51, 32768
    s_nop 0
    buffer_load_dwordx4 v9, s[16:19], s64 offen offset:3072 lds
    s_add_u32 m0, s51, 49152
    s_add_u32 s64, s53, 528512
    buffer_load_dwordx4 v8, s[16:19], s64 offen lds
    s_add_u32 m0, s51, 49152
    s_nop 0
    buffer_load_dwordx4 v9, s[16:19], s64 offen offset:1024 lds
    s_add_u32 m0, s51, 49152
    s_add_u32 s64, s53, 570496
    buffer_load_dwordx4 v8, s[16:19], s64 offen offset:2048 lds
    s_add_u32 m0, s51, 49152
    s_nop 0
    buffer_load_dwordx4 v9, s[16:19], s64 offen offset:3072 lds
    ds_read_b32 v25, v0 offset:1024
    s_waitcnt lgkmcnt(0)
    s_setprio 3
    v_cmp_gt_u32 vcc, 15, v25
    s_setprio 0
    s_cbranch_vccnz L_chk14
L_chk14_x:
    s_add_u32 m0, s1, 0
    s_add_u32 s43, s52, 10240
    buffer_load_dwordx4 v21, s[28:31], s43 offen sc1 lds
    s_waitcnt vmcnt(0)
    ds_add_u32 v18, v19 offset:512
    ds_read_b32 v25, v0 offset:1024
    s_waitcnt lgkmcnt(0)
    s_setprio 3
    v_cmp_gt_u32 vcc, 16, v25
    s_setprio 0
    s_cbranch_vccnz L_chk15
L_chk15_x:
    s_add_u32 m0, s1, 1056
    s_add_u32 s43, s52, 11264
    buffer_load_dwordx4 v21, s[28:31], s43 offen sc1 lds
    ds_read_b32 v25, v0 offset:1024
    s_waitcnt lgkmcnt(0)
    s_setprio 3
    v_cmp_gt_u32 vcc, 17, v25
    s_setprio 0
    s_cbranch_vccnz L_chk16
L_chk16_x:
    s_add_u32 m0, s1, 2112
    s_add_u32 s43, s52, 12288
    buffer_load_dwordx4 v21, s[28:31], s43 offen sc1 lds
    ds_read_b32 v25, v0 offset:1024
    s_waitcnt lgkmcnt(0)
    s_setprio 3
    v_cmp_gt_u32 vcc, 17, v25
    s_setprio 0
    s_cbranch_vccnz L_chk17
L_chk17_x:
    s_add_u32 m0, s1, 3168
    s_add_u32 s43, s52, 13312
    buffer_load_dwordx4 v21, s[28:31], s43 offen sc1 lds
    s_waitcnt vmcnt(0)
    ds_add_u32 v18, v19
    s_add_u32 s56, s56, 1
    s_setprio 3
    v_mov_b32 v20, 0
    v_mov_b32 v25, 0
    s_setprio 0
    s_branch L_ffn8
L_ffn:
    ds_read_b32 v20, v0 offset:0
    s_waitcnt lgkmcnt(0)
    s_setprio 3
    v_cmp_gt_u32 vcc, s56, v20
    s_setprio 0
    s_cbranch_vccnz L_chk18
L_chk18_x:
    s_add_u32 s56, s56, 1
    s_add_u32 m0, s51, 81920
    s_add_u32 s64, s53, 176128
    buffer_load_dwordx4 v8, s[16:19], s64 offen lds
    s_add_u32 m0, s51, 81920
    s_nop 0
    buffer_load_dwordx4 v9, s[16:19], s64 offen offset:1024 lds
    s_add_u32 m0, s51, 81920
    s_add_u32 s64, s53, 218112
    buffer_load_dwordx4 v8, s[16:19], s64 offen offset:2048 lds
    s_add_u32 m0, s51, 81920
    s_nop 0
    buffer_load_dwordx4 v9, s[16:19], s64 offen offset:3072 lds
    s_add_u32 m0, s51, 98304
    s_add_u32 s64, s53, 352256
    buffer_load_dwordx4 v8, s[16:19], s64 offen lds
    s_add_u32 m0, s51, 98304
    s_nop 0
    buffer_load_dwordx4 v9, s[16:19], s64 offen offset:1024 lds
    s_add_u32 m0, s51, 98304
    s_add_u32 s64, s53, 394240
    buffer_load_dwordx4 v8, s[16:19], s64 offen offset:2048 lds
    s_add_u32 m0, s51, 98304
    s_nop 0
    buffer_load_dwordx4 v9, s[16:19], s64 offen offset:3072 lds
    ds_read_b64_tr_b16 v[32:33], v13 offset:0
    ds_read_b64_tr_b16 v[34:35], v13 offset:512
    ds_read_b64_tr_b16 v[36:37], v13 offset:8192
    ds_read_b64_tr_b16 v[38:39], v13 offset:8704
    s_add_u32 m0, s51, 114688
    s_add_u32 s64, s53, 528384
    buffer_load_dwordx4 v8, s[16:19], s64 offen lds
    ds_read_b64_tr_b16 v[112:113], v13 offset:2048
    ds_read_b64_tr_b16 v[114:115], v13 offset:2560
    s_waitcnt vmcnt(5)
    ds_add_u32 v18, v19
    ds_read_b64_tr_b16 v[116:117], v13 offset:10240
    ds_read_b64_tr_b16 v[118:119], v13 offset:10752
    s_add_u32 m0, s51, 114688
    s_nop 0
    buffer_load_dwordx4 v9, s[16:19], s64 offen offset:1024 lds
    ds_read_b64_tr_b16 v[120:121], v13 offset:4096
    ds_read_b64_tr_b16 v[122:123], v13 offset:4608
    ds_read_b64_tr_b16 v[124:125], v13 offset:12288
    ds_read_b64_tr_b16 v[126:127], v13 offset:12800
    s_add_u32 m0, s51, 114688
    s_add_u32 s64, s53, 570368
    buffer_load_dwordx4 v8, s[16:19], s64 offen offset:2048 lds
    s_waitcnt lgkmcnt(9)
    v_mfma_f32_32x32x16_bf16 v[40:55], v[32:35], a[0:3], 0
    ds_read_b64_tr_b16 v[32:33], v13 offset:6144
    ds_read_b64_tr_b16 v[34:35], v13 offset:6656
    ds_read_b32 v20, v0 offset:0
    v_mfma_f32_32x32x16_bf16 v[56:71], v[36:39], a[0:3], 0
    ds_read_b64_tr_b16 v[36:37], v13 offset:14336
    ds_read_b64_tr_b16 v[38:39], v13 offset:14848
    s_add_u32 m0, s51, 114688
    s_nop 0
    buffer_load_dwordx4 v9, s[16:19], s64 offen offset:3072 lds
    s_waitcnt lgkmcnt(9)
    v_mfma_f32_32x32x16_bf16 v[40:55], v[112:115], a[4:7], v[40:55]
    s_waitcnt lgkmcnt(2)
    s_setprio 3
    v_cmp_gt_u32 vcc, s56, v20
    s_setprio 0
    s_cbranch_vccnz L_chk19
L_chk19_x:
    s_add_u32 s56, s56, 1
    ds_read_b64_tr_b16 v[112:113], v13 offset:16384
    ds_read_b64_tr_b16 v[114:115], v13 offset:16896
    v_mfma_f32_32x32x16_bf16 v[56:71], v[116:119], a[4:7], v[56:71]
    ds_read_b64_tr_b16 v[116:117], v13 offset:24576
    ds_read_b64_tr_b16 v[118:119], v13 offset:25088
    v_mfma_f32_32x32x16_bf16 v[40:55], v[120:123], a[8:11], v[40:55]
    ds_read_b64_tr_b16 v[120:121], v13 offset:18432
    ds_read_b64_tr_b16 v[122:123], v13 offset:18944
    s_waitcnt vmcnt(4)
    ds_add_u32 v18, v19
    v_mfma_f32_32x32x16_bf16 v[56:71], v[124:127], a[8:11], v[56:71]
    ds_read_b64_tr_b16 v[124:125], v13 offset:26624
    ds_read_b64_tr_b16 v[126:127], v13 offset:27136
    s_waitcnt lgkmcnt(9)
    v_mfma_f32_32x32x16_bf16 v[40:55], v[32:35], a[12:15], v[40:55]
    ds_read_b64_tr_b16 v[32:33], v13 offset:20480
    ds_read_b64_tr_b16 v[34:35], v13 offset:20992
    v_mfma_f32_32x32x16_bf16 v[56:71], v[36:39], a[12:15], v[56:71]
    ds_read_b64_tr_b16 v[36:37], v13 offset:28672
    ds_read_b64_tr_b16 v[38:39], v13 offset:29184
    s_waitcnt lgkmcnt(9)
    v_mfma_f32_32x32x16_bf16 v[40:55], v[112:115], a[16:19], v[40:55]
    ds_read_b64_tr_b16 v[112:113], v13 offset:22528
    ds_read_b64_tr_b16 v[114:115], v13 offset:23040
    ds_read_b32 v20, v0 offset:0
    v_mfma_f32_32x32x16_bf16 v[56:71], v[116:119], a[16:19], v[56:71]
    ds_read_b64_tr_b16 v[116:117], v13 offset:30720
    ds_read_b64_tr_b16 v[118:119], v13 offset:31232
    s_waitcnt lgkmcnt(9)
    v_mfma_f32_32x32x16_bf16 v[40:55], v[120:123], a[20:23], v[40:55]
    s_waitcnt lgkmcnt(2)
    s_setprio 3
    v_cmp_gt_u32 vcc, s56, v20
    s_setprio 0
    s_cbranch_vccnz L_chk20
L_chk20_x:
    s_add_u32 s56, s56, 1
    ds_read_b64_tr_b16 v[120:121], v13 offset:32768
    ds_read_b64_tr_b16 v[122:123], v13 offset:33280
    v_mfma_f32_32x32x16_bf16 v[56:71], v[124:127], a[20:23], v[56:71]
    ds_read_b64_tr_b16 v[124:125], v13 offset:40960
    ds_read_b64_tr_b16 v[126:127], v13 offset:41472
    v_mfma_f32_32x32x16_bf16 v[40:55], v[32:35], a[24:27], v[40:55]
    ds_read_b64_tr_b16 v[32:33], v13 offset:34816
    ds_read_b64_tr_b16 v[34:35], v13 offset:35328
    s_waitcnt vmcnt(0)
    ds_add_u32 v18, v19
    v_mfma_f32_32x32x16_bf16 v[56:71], v[36:39], a[24:27], v[56:71]
    ds_read_b64_tr_b16 v[36:37], v13 offset:43008
    ds_read_b64_tr_b16 v[38:39], v13 offset:43520
    s_waitcnt lgkmcnt(9)
    v_mfma_f32_32x32x16_bf16 v[40:55], v[112:115], a[28:31], v[40:55]
    ds_read_b64_tr_b16 v[112:113], v13 offset:36864
    ds_read_b64_tr_b16 v[114:115], v13 offset:37376
    v_mfma_f32_32x32x16_bf16 v[56:71], v[116:119], a[28:31], v[56:71]
    ds_read_b64_tr_b16 v[116:117], v13 offset:45056
    ds_read_b64_tr_b16 v[118:119], v13 offset:45568
    s_waitcnt lgkmcnt(9)
    v_mfma_f32_32x32x16_bf16 v[40:55], v[120:123], a[32:35], v[40:55]
    ds_read_b64_tr_b16 v[120:121], v13 offset:38912
    ds_read_b64_tr_b16 v[122:123], v13 offset:39424
    ds_read_b32 v20, v0 offset:0
    v_mfma_f32_32x32x16_bf16 v[56:71], v[124:127], a[32:35], v[56:71]
    ds_read_b64_tr_b16 v[124:125], v13 offset:47104
    ds_read_b64_tr_b16 v[126:127], v13 offset:47616
    s_waitcnt lgkmcnt(9)
    v_mfma_f32_32x32x16_bf16 v[40:55], v[32:35], a[36:39], v[40:55]
    s_waitcnt lgkmcnt(2)
    s_setprio 3
    v_cmp_gt_u32 vcc, s56, v20
    s_setprio 0
    s_cbranch_vccnz L_chk21
L_chk21_x:
    s_add_u32 s56, s56, 1
    ds_read_b32 v20, v0 offset:1024
    s_waitcnt lgkmcnt(0)
    s_setprio 3
    v_cmp_gt_u32 vcc, 14, v20
    s_setprio 0
    s_cbranch_vccnz L_chk22
L_chk22_x:
    s_add_u32 m0, s1, 5280
    s_add_u32 s43, s52, 5120
    buffer_load_dwordx4 v21, s[28:31], s43 offen sc1 lds
    s_add_u32 m0, s1, 6336
    s_add_u32 s43, s52, 6144
    buffer_load_dwordx4 v21, s[28:31], s43 offen sc1 lds
    s_add_u32 m0, s1, 7392
    s_add_u32 s43, s52, 7168
    buffer_load_dwordx4 v21, s[28:31], s43 offen sc1 lds
    s_add_u32 m0, s1, 8448
    s_add_u32 s43, s52, 8192
    buffer_load_dwordx4 v21, s[28:31], s43 offen sc1 lds
    s_add_u32 m0, s1, 9504
    s_add_u32 s43, s52, 9216
    buffer_load_dwordx4 v21, s[28:31], s43 offen sc1 lds
    s_add_u32 m0, s51, 32768
    s_add_u32 s64, s53, 704512
    buffer_load_dwordx4 v8, s[16:19], s64 offen lds
    s_add_u32 m0, s51, 32768
    s_nop 0
    buffer_load_dwordx4 v9, s[16:19], s64 offen offset:1024 lds
    s_add_u32 m0, s51, 32768
    s_add_u32 s64, s53, 746496
    buffer_load_dwordx4 v8, s[16:19], s64 offen offset:2048 lds
    s_add_u32 m0, s51, 32768
    s_nop 0
    buffer_load_dwordx4 v9, s[16:19], s64 offen offset:3072 lds
    ds_read_b64_tr_b16 v[32:33], v13 offset:49152
    ds_read_b64_tr_b16 v[34:35], v13 offset:49664
    s_add_u32 m0, s51, 49152
    s_add_u32 s64, s53, 880640
    buffer_load_dwordx4 v8, s[16:19], s64 offen lds
    v_mfma_f32_32x32x16_bf16 v[56:71], v[36:39], a[36:39], v[56:71]
    ds_read_b64_tr_b16 v[36:37], v13 offset:57344
    ds_read_b64_tr_b16 v[38:39], v13 offset:57856
    s_add_u32 m0, s51, 49152
    s_nop 0
    buffer_load_dwordx4 v9, s[16:19], s64 offen offset:1024 lds
    v_mfma_f32_32x32x16_bf16 v[40:55], v[112:115], a[40:43], v[40:55]
    ds_read_b64_tr_b16 v[112:113], v13 offset:51200
    ds_read_b64_tr_b16 v[114:115], v13 offset:51712
    s_waitcnt vmcnt(2)
    ds_add_u32 v18, v19
    s_add_u32 m0, s51, 49152
    s_add_u32 s64, s53, 922624
    buffer_load_dwordx4 v8, s[16:19], s64 offen offset:2048 lds
    v_mfma_f32_32x32x16_bf16 v[56:71], v[116:119], a[40:43], v[56:71]
    ds_read_b64_tr_b16 v[116:117], v13 offset:59392
    ds_read_b64_tr_b16 v[118:119], v13 offset:59904
    s_add_u32 m0, s51, 49152
    s_nop 0
    buffer_load_dwordx4 v9, s[16:19], s64 offen offset:3072 lds
    ds_add_u32 v18, v19 offset:512
    ds_add_u32 v18, v19 offset:512
    ds_add_u32 v18, v19 offset:512
    ds_add_u32 v18, v19 offset:512
    ds_add_u32 v18, v19 offset:512
    v_mfma_f32_32x32x16_bf16 v[40:55], v[120:123], a[44:47], v[40:55]
    ds_read_b64_tr_b16 v[120:121], v13 offset:53248
    s_waitcnt lgkmcnt(12)
    ds_read_b64_tr_b16 v[122:123], v13 offset:53760
    s_add_u32 m0, s51, 65536
    s_add_u32 s64, s53, 1056768
    buffer_load_dwordx4 v8, s[16:19], s64 offen lds
    v_mfma_f32_32x32x16_bf16 v[56:71], v[124:127], a[44:47], v[56:71]
    ds_read_b64_tr_b16 v[124:125], v13 offset:61440
    ds_read_b64_tr_b16 v[126:127], v13 offset:61952
    s_add_u32 m0, s51, 65536
    s_nop 0
    buffer_load_dwordx4 v9, s[16:19], s64 offen offset:1024 lds
    s_waitcnt lgkmcnt(14)
    v_mfma_f32_32x32x16_bf16 v[40:55], v[32:35], a[48:51], v[40:55]
    ds_read_b64_tr_b16 v[32:33], v13 offset:55296
    s_waitcnt lgkmcnt(12)
    ds_read_b64_tr_b16 v[34:35], v13 offset:55808
    s_add_u32 m0, s51, 65536
    s_add_u32 s64, s53, 1098752
    buffer_load_dwordx4 v8, s[16:19], s64 offen offset:2048 lds
    ds_read_b32 v20, v0 offset:0
    v_mfma_f32_32x32x16_bf16 v[56:71], v[36:39], a[48:51], v[56:71]
    ds_read_b64_tr_b16 v[36:37], v13 offset:63488
    s_waitcnt lgkmcnt(12)
    ds_read_b64_tr_b16 v[38:39], v13 offset:64000
    s_add_u32 m0, s51, 65536
    s_nop 0
    buffer_load_dwordx4 v9, s[16:19], s64 offen offset:3072 lds
    v_mfma_f32_32x32x16_bf16 v[40:55], v[112:115], a[52:55], v[40:55]
    s_waitcnt lgkmcnt(2)
    s_setprio 3
    v_cmp_gt_u32 vcc, s56, v20
    s_setprio 0
    s_cbranch_vccnz L_chk23
L_chk23_x:
    s_add_u32 s56, s56, 1
    ds_read_b64_tr_b16 v[112:113], v12 offset:32768
    ds_read_b64_tr_b16 v[114:115], v12 offset:33280
    s_add_u32 m0, s51, 81920
    s_add_u32 s64, s53, 1232896
    buffer_load_dwordx4 v8, s[16:19], s64 offen lds
    ds_read_b32 v25, v0 offset:1024
    v_mfma_f32_32x32x16_bf16 v[56:71], v[116:119], a[52:55], v[56:71]
    ds_read_b64_tr_b16 v[116:117], v12 offset:40960
    ds_read_b64_tr_b16 v[118:119], v12 offset:41472
    s_add_u32 m0, s51, 81920
    s_nop 0
    buffer_load_dwordx4 v9, s[16:19], s64 offen offset:1024 lds
    v_mfma_f32_32x32x16_bf16 v[40:55], v[120:123], a[56:59], v[40:55]
    ds_read_b64_tr_b16 v[120:121], v12 offset:34816
    ds_read_b64_tr_b16 v[122:123], v12 offset:35328
    s_waitcnt vmcnt(6)
    ds_add_u32 v18, v19
    s_add_u32 m0, s51, 81920
    s_add_u32 s64, s53, 1274880
    buffer_load_dwordx4 v8, s[16:19], s64 offen offset:2048 lds
    s_waitcnt lgkmcnt(5)
    s_setprio 3
    v_cmp_gt_u32 vcc, 15, v25
    s_setprio 0
    s_cbranch_vccnz L_chk24
L_chk24_x:
    v_mfma_f32_32x32x16_bf16 v[56:71], v[124:127], a[56:59], v[56:71]
    ds_read_b64_tr_b16 v[124:125], v12 offset:43008
    ds_read_b64_tr_b16 v[126:127], v12 offset:43520
    s_add_u32 m0, s51, 81920
    s_nop 0
    buffer_load_dwordx4 v9, s[16:19], s64 offen offset:3072 lds
    v_mfma_f32_32x32x16_bf16 v[40:55], v[32:35], a[60:63], v[40:55]
    ds_read_b64_tr_b16 v[32:33], v12 offset:36864
    ds_read_b64_tr_b16 v[34:35], v12 offset:37376
    s_add_u32 m0, s51, 98304
    s_add_u32 s64, s53, 128
    buffer_load_dwordx4 v8, s[16:19], s64 offen lds
    s_add_u32 m0, s1, 0
    s_add_u32 s43, s52, 10240
    buffer_load_dwordx4 v21, s[28:31], s43 offen sc1 lds
    v_mfma_f32_32x32x16_bf16 v[56:71], v[36:39], a[60:63], v[56:71]
    ds_read_b64_tr_b16 v[36:37], v12 offset:45056
    ds_read_b64_tr_b16 v[38:39], v12 offset:45568
    s_add_u32 m0, s51, 98304
    s_nop 0
    buffer_load_dwordx4 v9, s[16:19], s64 offen offset:1024 lds
    s_waitcnt lgkmcnt(9)
    v_mfma_f32_32x32x16_bf16 v[40:55], v[112:115], a[64:67], v[40:55]
    ds_read_b64_tr_b16 v[112:113], v12 offset:38912
    ds_read_b64_tr_b16 v[114:115], v12 offset:39424
    s_add_u32 m0, s51, 98304
    s_add_u32 s64, s53, 42112
    buffer_load_dwordx4 v8, s[16:19], s64 offen offset:2048 lds
    ds_read_b32 v20, v0 offset:0
    v_mfma_f32_32x32x16_bf16 v[56:71], v[116:119], a[64:67], v[56:71]
    ds_read_b64_tr_b16 v[116:117], v12 offset:47104
    ds_read_b64_tr_b16 v[118:119], v12 offset:47616
    s_add_u32 m0, s51, 98304
    s_nop 0
    buffer_load_dwordx4 v9, s[16:19], s64 offen offset:3072 lds
    s_waitcnt lgkmcnt(9)
    v_mfma_f32_32x32x16_bf16 v[40:55], v[120:123], a[68:71], v[40:55]
    s_waitcnt lgkmcnt(2)
    s_setprio 3
    v_cmp_gt_u32 vcc, s56, v20
    s_setprio 0
    s_cbranch_vccnz L_chk25
L_chk25_x:
    s_add_u32 s56, s56, 1
    ds_read_b64_tr_b16 v[120:121], v12 offset:49152
    ds_read_b64_tr_b16 v[122:123], v12 offset:49664
    ds_read_b32 v25, v0 offset:1024
    v_mfma_f32_32x32x16_bf16 v[56:71], v[124:127], a[68:71], v[56:71]
    ds_read_b64_tr_b16 v[124:125], v12 offset:57344
    ds_read_b64_tr_b16 v[126:127], v12 offset:57856
    s_add_u32 m0, s51, 114688
    s_add_u32 s64, s53, 176256
    buffer_load_dwordx4 v8, s[16:19], s64 offen lds
    v_mfma_f32_32x32x16_bf16 v[40:55], v[32:35], a[72:75], v[40:55]
    ds_read_b64_tr_b16 v[32:33], v12 offset:51200
    ds_read_b64_tr_b16 v[34:35], v12 offset:51712
    s_waitcnt vmcnt(10)
    ds_add_u32 v18, v19
    s_waitcnt lgkmcnt(5)
    s_setprio 3
    v_cmp_gt_u32 vcc, 16, v25
    s_setprio 0
    s_cbranch_vccnz L_chk26
L_chk26_x:
    v_mfma_f32_32x32x16_bf16 v[56:71], v[36:39], a[72:75], v[56:71]
    ds_read_b64_tr_b16 v[36:37], v12 offset:59392
    ds_read_b64_tr_b16 v[38:39], v12 offset:59904
    s_add_u32 m0, s51, 114688
    s_nop 0
    buffer_load_dwordx4 v9, s[16:19], s64 offen offset:1024 lds
    v_mfma_f32_32x32x16_bf16 v[40:55], v[112:115], a[76:79], v[40:55]
    ds_read_b64_tr_b16 v[112:113], v12 offset:53248
    ds_read_b64_tr_b16 v[114:115], v12 offset:53760
    s_add_u32 m0, s1, 1056
    s_add_u32 s43, s52, 11264
    buffer_load_dwordx4 v21, s[28:31], s43 offen sc1 lds
    v_mfma_f32_32x32x16_bf16 v[56:71], v[116:119], a[76:79], v[56:71]
    ds_read_b64_tr_b16 v[116:117], v12 offset:61440
    ds_read_b64_tr_b16 v[118:119], v12 offset:61952
    s_add_u32 m0, s51, 114688
    s_add_u32 s64, s53, 218240
    buffer_load_dwordx4 v8, s[16:19], s64 offen offset:2048 lds
    s_waitcnt lgkmcnt(9)
    v_mfma_f32_32x32x16_bf16 v[40:55], v[120:123], a[80:83], v[40:55]
    ds_read_b64_tr_b16 v[120:121], v12 offset:55296
    ds_read_b64_tr_b16 v[122:123], v12 offset:55808
    ds_read_b32 v20, v0 offset:0
    v_mfma_f32_32x32x16_bf16 v[56:71], v[124:127], a[80:83], v[56:71]
    ds_read_b64_tr_b16 v[124:125], v12 offset:63488
    ds_read_b64_tr_b16 v[126:127], v12 offset:64000
    s_add_u32 m0, s51, 114688
    s_nop 0
    buffer_load_dwordx4 v9, s[16:19], s64 offen offset:3072 lds
    s_waitcnt lgkmcnt(9)
    v_mfma_f32_32x32x16_bf16 v[40:55], v[32:35], a[84:87], v[40:55]
    s_waitcnt lgkmcnt(2)
    s_setprio 3
    v_cmp_gt_u32 vcc, s56, v20
    s_setprio 0
    s_cbranch_vccnz L_chk27
L_chk27_x:
    s_add_u32 s56, s56, 1
    ds_read_b64_tr_b16 v[32:33], v13 offset:0
    ds_read_b64_tr_b16 v[34:35], v13 offset:512
    ds_read_b32 v25, v0 offset:1024
    v_mfma_f32_32x32x16_bf16 v[56:71], v[36:39], a[84:87], v[56:71]
    ds_read_b64_tr_b16 v[36:37], v13 offset:8192
    ds_read_b64_tr_b16 v[38:39], v13 offset:8704
    s_add_u32 m0, s51, 32768
    s_add_u32 s64, s53, 352384
    buffer_load_dwordx4 v8, s[16:19], s64 offen lds
    v_mfma_f32_32x32x16_bf16 v[40:55], v[112:115], a[88:91], v[40:55]
    ds_read_b64_tr_b16 v[112:113], v13 offset:2048
    ds_read_b64_tr_b16 v[114:115], v13 offset:2560
    s_waitcnt vmcnt(11)
    ds_add_u32 v18, v19
    s_waitcnt lgkmcnt(5)
    s_setprio 3
    v_cmp_gt_u32 vcc, 17, v25
    s_setprio 0
    s_cbranch_vccnz L_chk28
L_chk28_x:
    v_mfma_f32_32x32x16_bf16 v[56:71], v[116:119], a[88:91], v[56:71]
    ds_read_b64_tr_b16 v[116:117], v13 offset:10240
    ds_read_b64_tr_b16 v[118:119], v13 offset:10752
    s_add_u32 m0, s51, 32768
    s_nop 0
    buffer_load_dwordx4 v9, s[16:19], s64 offen offset:1024 lds
    v_mfma_f32_32x32x16_bf16 v[40:55], v[120:123], a[92:95], v[40:55]
    ds_read_b64_tr_b16 v[120:121], v13 offset:4096
    ds_read_b64_tr_b16 v[122:123], v13 offset:4608
    s_add_u32 m0, s1, 2112
    s_add_u32 s43, s52, 12288
    buffer_load_dwordx4 v21, s[28:31], s43 offen sc1 lds
    v_mfma_f32_32x32x16_bf16 v[56:71], v[124:127], a[92:95], v[56:71]
    ds_read_b64_tr_b16 v[124:125], v13 offset:12288
    ds_read_b64_tr_b16 v[126:127], v13 offset:12800
    s_add_u32 m0, s51, 32768
    s_add_u32 s64, s53, 394368
    buffer_load_dwordx4 v8, s[16:19], s64 offen offset:2048 lds
    s_waitcnt lgkmcnt(9)
    v_mfma_f32_32x32x16_bf16 v[40:55], v[32:35], a[96:99], v[40:55]
    ds_read_b64_tr_b16 v[32:33], v13 offset:6144
    ds_read_b64_tr_b16 v[34:35], v13 offset:6656
    ds_read_b32 v20, v0 offset:0
    v_mfma_f32_32x32x16_bf16 v[56:71], v[36:39], a[96:99], v[56:71]
    ds_read_b64_tr_b16 v[36:37], v13 offset:14336
    ds_read_b64_tr_b16 v[38:39], v13 offset:14848
    s_add_u32 m0, s51, 32768
    s_nop 0
    buffer_load_dwordx4 v9, s[16:19], s64 offen offset:3072 lds
    s_waitcnt lgkmcnt(9)
    v_mfma_f32_32x32x16_bf16 v[40:55], v[112:115], a[100:103], v[40:55]
    s_waitcnt lgkmcnt(2)
    s_setprio 3
    v_cmp_gt_u32 vcc, s56, v20
    s_setprio 0
    s_cbranch_vccnz L_chk29
L_chk29_x:
    s_add_u32 s56, s56, 1
    ds_read_b64_tr_b16 v[112:113], v13 offset:16384
    ds_read_b64_tr_b16 v[114:115], v13 offset:16896
    s_waitcnt vmcnt(13)
    ds_add_u32 v18, v19 offset:512
    v_mfma_f32_32x32x16_bf16 v[56:71], v[116:119], a[100:103], v[56:71]
    ds_read_b64_tr_b16 v[116:117], v13 offset:24576
    ds_read_b64_tr_b16 v[118:119], v13 offset:25088
    s_add_u32 m0, s51, 49152
    s_add_u32 s64, s53, 528512
    buffer_load_dwordx4 v8, s[16:19], s64 offen lds
    v_mfma_f32_32x32x16_bf16 v[40:55], v[120:123], a[104:107], v[40:55]
    ds_read_b64_tr_b16 v[120:121], v13 offset:18432
    ds_read_b64_tr_b16 v[122:123], v13 offset:18944
    s_waitcnt vmcnt(11)
    ds_add_u32 v18, v19
    v_mfma_f32_32x32x16_bf16 v[56:71], v[124:127], a[104:107], v[56:71]
    ds_read_b64_tr_b16 v[124:125], v13 offset:26624
    ds_read_b64_tr_b16 v[126:127], v13 offset:27136
    s_add_u32 m0, s51, 49152
    s_nop 0
    buffer_load_dwordx4 v9, s[16:19], s64 offen offset:1024 lds
    s_waitcnt lgkmcnt(10)
    v_mfma_f32_32x32x16_bf16 v[40:55], v[32:35], a[108:111], v[40:55]
    ds_read_b64_tr_b16 v[32:33], v13 offset:20480
    ds_read_b64_tr_b16 v[34:35], v13 offset:20992
    s_add_u32 m0, s1, 3168
    s_add_u32 s43, s52, 13312
    buffer_load_dwordx4 v21, s[28:31], s43 offen sc1 lds
    v_mfma_f32_32x32x16_bf16 v[56:71], v[36:39], a[108:111], v[56:71]
    ds_read_b64_tr_b16 v[36:37], v13 offset:28672
    ds_read_b64_tr_b16 v[38:39], v13 offset:29184
    s_add_u32 m0, s51, 49152
    s_add_u32 s64, s53, 570496
    buffer_load_dwordx4 v8, s[16:19], s64 offen offset:2048 lds
    s_waitcnt lgkmcnt(9)
    v_mfma_f32_32x32x16_bf16 v[40:55], v[112:115], v[96:99], v[40:55]
    ds_read_b64_tr_b16 v[112:113], v13 offset:22528
    ds_read_b64_tr_b16 v[114:115], v13 offset:23040
    ds_read_b32 v20, v0 offset:0
    v_mfma_f32_32x32x16_bf16 v[56:71], v[116:119], v[96:99], v[56:71]
    ds_read_b64_tr_b16 v[116:117], v13 offset:30720
    ds_read_b64_tr_b16 v[118:119], v13 offset:31232
    s_add_u32 m0, s51, 49152
    s_nop 0
    buffer_load_dwordx4 v9, s[16:19], s64 offen offset:3072 lds
    s_waitcnt lgkmcnt(9)
    v_mfma_f32_32x32x16_bf16 v[40:55], v[120:123], v[100:103], v[40:55]
L_ffn8:
    s_waitcnt lgkmcnt(2)
    s_setprio 3
    v_cmp_gt_u32 vcc, s56, v20
    s_setprio 0
    s_cbranch_vccnz L_chk30
L_chk30_x:
    s_add_u32 s56, s56, 1
    ds_read_b64_tr_b16 v[120:121], v13 offset:32768
    ds_read_b64_tr_b16 v[122:123], v13 offset:33280
    s_waitcnt vmcnt(12)
    ds_add_u32 v18, v19 offset:512
    ds_read_b32 v25, v0 offset:1024
    v_mfma_f32_32x32x16_bf16 v[56:71], v[124:127], v[100:103], v[56:71]
    ds_read_b64_tr_b16 v[124:125], v13 offset:40960
    ds_read_b64_tr_b16 v[126:127], v13 offset:41472
    s_add_u32 m0, s51, 65536
    s_add_u32 s64, s53, 704640
    buffer_load_dwordx4 v8, s[16:19], s64 offen lds
    v_mfma_f32_32x32x16_bf16 v[40:55], v[32:35], v[104:107], v[40:55]
    ds_read_b64_tr_b16 v[32:33], v13 offset:34816
    ds_read_b64_tr_b16 v[34:35], v13 offset:35328
    s_waitcnt vmcnt(11)
    ds_add_u32 v18, v19
    s_waitcnt lgkmcnt(5)
    s_setprio 3
    v_cmp_gt_u32 vcc, 18, v25
    s_setprio 0
    s_cbranch_vccnz L_chk31
L_chk31_x:
    v_mfma_f32_32x32x16_bf16 v[56:71], v[36:39], v[104:107], v[56:71]
    ds_read_b64_tr_b16 v[36:37], v13 offset:43008
    ds_read_b64_tr_b16 v[38:39], v13 offset:43520
    s_add_u32 m0, s51, 65536
    s_nop 0
    buffer_load_dwordx4 v9, s[16:19], s64 offen offset:1024 lds
    v_mfma_f32_32x32x16_bf16 v[40:55], v[112:115], v[108:111], v[40:55]
    ds_read_b64_tr_b16 v[112:113], v13 offset:36864
    ds_read_b64_tr_b16 v[114:115], v13 offset:37376
    s_add_u32 m0, s1, 4224
    s_add_u32 s43, s52, 14336
    buffer_load_dwordx4 v21, s[28:31], s43 offen sc1 lds
    v_mfma_f32_32x32x16_bf16 v[56:71], v[116:119], v[108:111], v[56:71]
    ds_read_b64_tr_b16 v[116:117], v13 offset:45056
    ds_read_b64_tr_b16 v[118:119], v13 offset:45568
    s_add_u32 m0, s51, 65536
    s_add_u32 s64, s53, 746624
    buffer_load_dwordx4 v8, s[16:19], s64 offen offset:2048 lds
    s_setprio 3
    s_nop 9
    v_pk_mul_f32 v[72:73], v[40:41], v[40:41]
    v_pk_mul_f32 v[74:75], v[42:43], v[42:43]
    v_pk_mul_f32 v[76:77], v[44:45], v[44:45]
    v_pk_mul_f32 v[78:79], v[46:47], v[46:47]
    v_pk_mul_f32 v[80:81], v[48:49], v[48:49]
    v_pk_mul_f32 v[82:83], v[50:51], v[50:51]
    v_pk_mul_f32 v[84:85], v[52:53], v[52:53]
    v_pk_mul_f32 v[86:87], v[54:55], v[54:55]
    v_pk_fma_f32 v[72:73], v[72:73], s[62:63], v[2:3]
    v_pk_fma_f32 v[74:75], v[74:75], s[62:63], v[2:3]
    v_pk_fma_f32 v[76:77], v[76:77], s[62:63], v[2:3]
    v_pk_fma_f32 v[78:79], v[78:79], s[62:63], v[2:3]
    v_pk_fma_f32 v[80:81], v[80:81], s[62:63], v[2:3]
    v_pk_fma_f32 v[82:83], v[82:83], s[62:63], v[2:3]
    v_pk_fma_f32 v[84:85], v[84:85], s[62:63], v[2:3]
    v_pk_fma_f32 v[86:87], v[86:87], s[62:63], v[2:3]
    v_pk_mul_f32 v[88:89], v[56:57], v[40:41]
    v_pk_mul_f32 v[90:91], v[58:59], v[42:43]
    v_pk_mul_f32 v[92:93], v[60:61], v[44:45]
    v_pk_mul_f32 v[94:95], v[62:63], v[46:47]
    v_pk_mul_f32 v[128:129], v[64:65], v[48:49]
    v_pk_mul_f32 v[130:131], v[66:67], v[50:51]
    v_pk_mul_f32 v[132:133], v[68:69], v[52:53]
    v_pk_mul_f32 v[134:135], v[70:71], v[54:55]
    v_pk_mul_f32 v[72:73], v[72:73], v[40:41]
    v_pk_mul_f32 v[74:75], v[74:75], v[42:43]
    v_pk_mul_f32 v[76:77], v[76:77], v[44:45]
    v_pk_mul_f32 v[78:79], v[78:79], v[46:47]
    v_pk_mul_f32 v[80:81], v[80:81], v[48:49]
    v_pk_mul_f32 v[82:83], v[82:83], v[50:51]
    v_pk_mul_f32 v[84:85], v[84:85], v[52:53]
    v_pk_mul_f32 v[86:87], v[86:87], v[54:55]
    s_setprio 0
    v_mfma_f32_32x32x16_bf16 v[40:55], v[120:123], a[0:3], 0
    s_setprio 3
    v_exp_f32 v72, v72
    v_exp_f32 v73, v73
    v_exp_f32 v74, v74
    v_exp_f32 v75, v75
    s_setprio 0
    ds_read_b64_tr_b16 v[120:121], v13 offset:38912
    ds_read_b64_tr_b16 v[122:123], v13 offset:39424
    ds_read_b32 v20, v0 offset:0
    s_waitcnt lgkmcnt(12)
    v_mfma_f32_32x32x16_bf16 v[56:71], v[124:127], a[0:3], 0
    s_setprio 3
    v_exp_f32 v76, v76
    v_exp_f32 v77, v77
    v_exp_f32 v78, v78
    v_exp_f32 v79, v79
    s_setprio 0
    ds_read_b64_tr_b16 v[124:125], v13 offset:47104
    ds_read_b64_tr_b16 v[126:127], v13 offset:47616
    s_add_u32 m0, s51, 65536
    s_nop 0
    buffer_load_dwordx4 v9, s[16:19], s64 offen offset:3072 lds
    s_waitcnt lgkmcnt(12)
    v_mfma_f32_32x32x16_bf16 v[40:55], v[32:35], a[4:7], v[40:55]
    s_setprio 3
    v_exp_f32 v80, v80
    v_exp_f32 v81, v81
    v_exp_f32 v82, v82
    v_exp_f32 v83, v83
    s_setprio 0
    s_waitcnt lgkmcnt(2)
    s_setprio 3
    v_cmp_gt_u32 vcc, s56, v20
    s_setprio 0
    s_cbranch_vccnz L_chk32
L_chk32_x:
    s_add_u32 s56, s56, 1
    ds_read_b64_tr_b16 v[32:33], v13 offset:49152
    ds_read_b64_tr_b16 v[34:35], v13 offset:49664
    s_waitcnt vmcnt(12)
    ds_add_u32 v18, v19 offset:512
    v_mfma_f32_32x32x16_bf16 v[56:71], v[36:39], a[4:7], v[56:71]
    s_setprio 3
    v_exp_f32 v84, v84
    v_exp_f32 v85, v85
    v_exp_f32 v86, v86
    v_exp_f32 v87, v87
    s_setprio 0
    ds_read_b64_tr_b16 v[36:37], v13 offset:57344
    ds_read_b64_tr_b16 v[38:39], v13 offset:57856
    s_add_u32 m0, s51, 81920
    s_add_u32 s64, s53, 880768
    buffer_load_dwordx4 v8, s[16:19], s64 offen lds
    v_mfma_f32_32x32x16_bf16 v[40:55], v[112:115], a[8:11], v[40:55]
    s_setprio 3
    v_pk_add_f32 v[72:73], v[72:73], 1.0 op_sel_hi:[1,0]
    v_pk_add_f32 v[74:75], v[74:75], 1.0 op_sel_hi:[1,0]
    v_pk_add_f32 v[76:77], v[76:77], 1.0 op_sel_hi:[1,0]
    v_pk_add_f32 v[78:79], v[78:79], 1.0 op_sel_hi:[1,0]
    v_pk_add_f32 v[80:81], v[80:81], 1.0 op_sel_hi:[1,0]
    v_pk_add_f32 v[82:83], v[82:83], 1.0 op_sel_hi:[1,0]
    v_pk_add_f32 v[84:85], v[84:85], 1.0 op_sel_hi:[1,0]
    v_pk_add_f32 v[86:87], v[86:87], 1.0 op_sel_hi:[1,0]
    s_setprio 0
    ds_read_b64_tr_b16 v[112:113], v13 offset:51200
    ds_read_b64_tr_b16 v[114:115], v13 offset:51712
    s_waitcnt vmcnt(11)
    ds_add_u32 v18, v19
    v_mfma_f32_32x32x16_bf16 v[56:71], v[116:119], a[8:11], v[56:71]
    s_setprio 3
    v_rcp_f32 v72, v72
    v_rcp_f32 v73, v73
    v_rcp_f32 v74, v74
    v_rcp_f32 v75, v75
    s_setprio 0
    ds_read_b64_tr_b16 v[116:117], v13 offset:59392
    ds_read_b64_tr_b16 v[118:119], v13 offset:59904
    s_add_u32 m0, s51, 81920
    s_nop 0
    buffer_load_dwordx4 v9, s[16:19], s64 offen offset:1024 lds
    v_mfma_f32_32x32x16_bf16 v[40:55], v[120:123], a[12:15], v[40:55]
    s_setprio 3
    v_rcp_f32 v76, v76
    v_rcp_f32 v77, v77
    v_rcp_f32 v78, v78
    v_rcp_f32 v79, v79
    s_setprio 0
    ds_read_b64_tr_b16 v[120:121], v13 offset:53248
    ds_read_b64_tr_b16 v[122:123], v13 offset:53760
    s_add_u32 m0, s1, 5280
    s_add_u32 s43, s52, 15360
    buffer_load_dwordx4 v21, s[28:31], s43 offen sc1 lds
    s_waitcnt lgkmcnt(12)
    v_mfma_f32_32x32x16_bf16 v[56:71], v[124:127], a[12:15], v[56:71]
    s_setprio 3
    v_rcp_f32 v80, v80
    v_rcp_f32 v81, v81
    v_rcp_f32 v82, v82
    v_rcp_f32 v83, v83
    s_setprio 0
    ds_read_b64_tr_b16 v[124:125], v13 offset:61440
    ds_read_b64_tr_b16 v[126:127], v13 offset:61952
    s_add_u32 m0, s51, 81920
    s_add_u32 s64, s53, 922752
    buffer_load_dwordx4 v8, s[16:19], s64 offen offset:2048 lds
    s_waitcnt lgkmcnt(12)
    v_mfma_f32_32x32x16_bf16 v[40:55], v[32:35], a[16:19], v[40:55]
    s_setprio 3
    v_rcp_f32 v84, v84
    v_rcp_f32 v85, v85
    v_rcp_f32 v86, v86
    v_rcp_f32 v87, v87
    s_setprio 0
    ds_read_b64_tr_b16 v[32:33], v13 offset:55296
    ds_read_b64_tr_b16 v[34:35], v13 offset:55808
    ds_read_b32 v20, v0 offset:0
    s_waitcnt lgkmcnt(12)
    v_mfma_f32_32x32x16_bf16 v[56:71], v[36:39], a[16:19], v[56:71]
    s_setprio 3
    v_pk_mul_f32 v[88:89], v[88:89], v[72:73]
    v_pk_mul_f32 v[90:91], v[90:91], v[74:75]
    v_pk_mul_f32 v[92:93], v[92:93], v[76:77]
    v_pk_mul_f32 v[94:95], v[94:95], v[78:79]
    v_pk_mul_f32 v[128:129], v[128:129], v[80:81]
    v_pk_mul_f32 v[130:131], v[130:131], v[82:83]
    v_pk_mul_f32 v[132:133], v[132:133], v[84:85]
    v_pk_mul_f32 v[134:135], v[134:135], v[86:87]
    s_setprio 0
    ds_read_b64_tr_b16 v[36:37], v13 offset:63488
    ds_read_b64_tr_b16 v[38:39], v13 offset:64000
    s_add_u32 m0, s51, 81920
    s_nop 0
    buffer_load_dwordx4 v9, s[16:19], s64 offen offset:3072 lds
    s_waitcnt lgkmcnt(12)
    v_mfma_f32_32x32x16_bf16 v[40:55], v[112:115], a[20:23], v[40:55]
    s_setprio 3
    v_cvt_pk_bf16_f32 v72, v88, v89
    v_cvt_pk_bf16_f32 v73, v90, v91
    v_cvt_pk_bf16_f32 v74, v92, v93
    v_cvt_pk_bf16_f32 v75, v94, v95
    v_cvt_pk_bf16_f32 v76, v128, v129
    v_cvt_pk_bf16_f32 v77, v130, v131
    v_cvt_pk_bf16_f32 v78, v132, v133
    v_cvt_pk_bf16_f32 v79, v134, v135
    s_setprio 0
    s_waitcnt lgkmcnt(2)
    s_setprio 3
    v_cmp_gt_u32 vcc, s56, v20
    s_setprio 0
    s_cbranch_vccnz L_chk33
L_chk33_x:
    s_add_u32 s56, s56, 1
    ds_read_b64_tr_b16 v[112:113], v12 offset:32768
    ds_read_b64_tr_b16 v[114:115], v12 offset:33280
    s_waitcnt vmcnt(12)
    ds_add_u32 v18, v19 offset:512
    ds_read_b32 v25, v0 offset:1024
    v_mfma_f32_32x32x16_bf16 v[56:71], v[116:119], a[20:23], v[56:71]
    s_cmp_eq_u32 s60, 3
    s_cbranch_scc1 L_hskip34
    s_add_u32 s43, s58, 0
    buffer_store_dwordx4 v[72:75], v21, s[28:31], s43 offen sc1
    buffer_store_dwordx4 v[76:79], v21, s[28:31], s43 offen offset:1024 sc1
L_hskip34:
    ds_read_b64_tr_b16 v[116:117], v12 offset:40960
    ds_read_b64_tr_b16 v[118:119], v12 offset:41472
    s_add_u32 m0, s51, 98304
    s_add_u32 s64, s53, 1056896
    buffer_load_dwordx4 v8, s[16:19], s64 offen lds
    v_mfma_f32_32x32x16_bf16 v[40:55], v[120:123], a[24:27], v[40:55]
    ds_read_b64_tr_b16 v[120:121], v12 offset:34816
    ds_read_b64_tr_b16 v[122:123], v12 offset:35328
    s_waitcnt vmcnt(11)
    ds_add_u32 v18, v19
    s_waitcnt lgkmcnt(5)
    s_setprio 3
    v_cmp_gt_u32 vcc, 19, v25
    s_setprio 0
    s_cbranch_vccnz L_chk35
L_chk35_x:
    v_mfma_f32_32x32x16_bf16 v[56:71], v[124:127], a[24:27], v[56:71]
    ds_read_b64_tr_b16 v[124:125], v12 offset:43008
    ds_read_b64_tr_b16 v[126:127], v12 offset:43520
    s_add_u32 m0, s51, 98304
    s_nop 0
    buffer_load_dwordx4 v9, s[16:19], s64 offen offset:1024 lds
    v_mfma_f32_32x32x16_bf16 v[40:55], v[32:35], a[28:31], v[40:55]
    ds_read_b64_tr_b16 v[32:33], v12 offset:36864
    ds_read_b64_tr_b16 v[34:35], v12 offset:37376
    s_add_u32 m0, s1, 6336
    s_add_u32 s43, s52, 16384
    buffer_load_dwordx4 v21, s[28:31], s43 offen sc1 lds
    v_mfma_f32_32x32x16_bf16 v[56:71], v[36:39], a[28:31], v[56:71]
    ds_read_b64_tr_b16 v[36:37], v12 offset:45056
    ds_read_b64_tr_b16 v[38:39], v12 offset:45568
    s_add_u32 m0, s51, 98304
    s_add_u32 s64, s53, 1098880
    buffer_load_dwordx4 v8, s[16:19], s64 offen offset:2048 lds
    s_waitcnt lgkmcnt(9)
    v_mfma_f32_32x32x16_bf16 v[40:55], v[112:115], a[32:35], v[40:55]
    ds_read_b64_tr_b16 v[112:113], v12 offset:38912
    ds_read_b64_tr_b16 v[114:115], v12 offset:39424
    ds_read_b32 v20, v0 offset:0
    v_mfma_f32_32x32x16_bf16 v[56:71], v[116:119], a[32:35], v[56:71]
    ds_read_b64_tr_b16 v[116:117], v12 offset:47104
    ds_read_b64_tr_b16 v[118:119], v12 offset:47616
    s_add_u32 m0, s51, 98304
    s_nop 0
    buffer_load_dwordx4 v9, s[16:19], s64 offen offset:3072 lds
    s_waitcnt lgkmcnt(9)
    v_mfma_f32_32x32x16_bf16 v[40:55], v[120:123], a[36:39], v[40:55]
    s_waitcnt lgkmcnt(2)
    s_setprio 3
    v_cmp_gt_u32 vcc, s56, v20
    s_setprio 0
    s_cbranch_vccnz L_chk36
L_chk36_x:
    s_add_u32 s56, s56, 1
    ds_read_b64_tr_b16 v[120:121], v12 offset:49152
    ds_read_b64_tr_b16 v[122:123], v12 offset:49664
    s_waitcnt vmcnt(12)
    ds_add_u32 v18, v19 offset:512
    v_mfma_f32_32x32x16_bf16 v[56:71], v[124:127], a[36:39], v[56:71]
    ds_read_b64_tr_b16 v[124:125], v12 offset:57344
    ds_read_b64_tr_b16 v[126:127], v12 offset:57856
    s_add_u32 m0, s51, 114688
    s_add_u32 s64, s53, 1233024
    buffer_load_dwordx4 v8, s[16:19], s64 offen lds
    v_mfma_f32_32x32x16_bf16 v[40:55], v[32:35], a[40:43], v[40:55]
    ds_read_b64_tr_b16 v[32:33], v12 offset:51200
    ds_read_b64_tr_b16 v[34:35], v12 offset:51712
    s_waitcnt vmcnt(11)
    ds_add_u32 v18, v19
    v_mfma_f32_32x32x16_bf16 v[56:71], v[36:39], a[40:43], v[56:71]
    ds_read_b64_tr_b16 v[36:37], v12 offset:59392
    ds_read_b64_tr_b16 v[38:39], v12 offset:59904
    s_add_u32 m0, s51, 114688
    s_nop 0
    buffer_load_dwordx4 v9, s[16:19], s64 offen offset:1024 lds
    s_waitcnt lgkmcnt(10)
    v_mfma_f32_32x32x16_bf16 v[40:55], v[112:115], a[44:47], v[40:55]
    ds_read_b64_tr_b16 v[112:113], v12 offset:53248
    ds_read_b64_tr_b16 v[114:115], v12 offset:53760
    s_add_u32 m0, s1, 7392
    s_add_u32 s43, s52, 17408
    buffer_load_dwordx4 v21, s[28:31], s43 offen sc1 lds
    v_mfma_f32_32x32x16_bf16 v[56:71], v[116:119], a[44:47], v[56:71]
    ds_read_b64_tr_b16 v[116:117], v12 offset:61440
    ds_read_b64_tr_b16 v[118:119], v12 offset:61952
    s_add_u32 m0, s51, 114688
    s_add_u32 s64, s53, 1275008
    buffer_load_dwordx4 v8, s[16:19], s64 offen offset:2048 lds
    s_waitcnt lgkmcnt(9)
    v_mfma_f32_32x32x16_bf16 v[40:55], v[120:123], a[48:51], v[40:55]
    ds_read_b64_tr_b16 v[120:121], v12 offset:55296
    ds_read_b64_tr_b16 v[122:123], v12 offset:55808
    ds_read_b32 v20, v0 offset:0
    s_waitcnt vmcnt(9)
    s_add_u32 s43, s61, 0
    s_mov_b64 exec, 1
    buffer_store_dword v22, v4, s[28:31], s43 offen sc1
    s_mov_b64 exec, -1
    v_mfma_f32_32x32x16_bf16 v[56:71], v[124:127], a[48:51], v[56:71]
    ds_read_b64_tr_b16 v[124:125], v12 offset:63488
    ds_read_b64_tr_b16 v[126:127], v12 offset:64000
    s_add_u32 m0, s51, 114688
    s_nop 0
    buffer_load_dwordx4 v9, s[16:19], s64 offen offset:3072 lds
    s_waitcnt lgkmcnt(9)
    v_mfma_f32_32x32x16_bf16 v[40:55], v[32:35], a[52:55], v[40:55]
    s_waitcnt lgkmcnt(2)
    s_setprio 3
    v_cmp_gt_u32 vcc, s56, v20
    s_setprio 0
    s_cbranch_vccnz L_chk37
L_chk37_x:
    s_add_u32 s56, s56, 1
    ds_read_b64_tr_b16 v[32:33], v13 offset:0
    ds_read_b64_tr_b16 v[34:35], v13 offset:512
    ds_add_u32 v18, v19 offset:512
    ds_read_b32 v25, v0 offset:1024
    v_mfma_f32_32x32x16_bf16 v[56:71], v[36:39], a[52:55], v[56:71]
    ds_read_b64_tr_b16 v[36:37], v13 offset:8192
    ds_read_b64_tr_b16 v[38:39], v13 offset:8704
    s_add_u32 m0, s51, 32768
    s_add_u32 s64, s53, 256
    buffer_load_dwordx4 v8, s[16:19], s64 offen lds
    v_mfma_f32_32x32x16_bf16 v[40:55], v[112:115], a[56:59], v[40:55]
    ds_read_b64_tr_b16 v[112:113], v13 offset:2048
    ds_read_b64_tr_b16 v[114:115], v13 offset:2560
    ds_add_u32 v18, v19
    s_waitcnt lgkmcnt(5)
    s_setprio 3
    v_cmp_gt_u32 vcc, 20, v25
    s_setprio 0
    s_cbranch_vccnz L_chk38
L_chk38_x:
    v_mfma_f32_32x32x16_bf16 v[56:71], v[116:119], a[56:59], v[56:71]
    ds_read_b64_tr_b16 v[116:117], v13 offset:10240
    ds_read_b64_tr_b16 v[118:119], v13 offset:10752
    s_add_u32 m0, s51, 32768
    s_nop 0
    buffer_load_dwordx4 v9, s[16:19], s64 offen offset:1024 lds
    v_mfma_f32_32x32x16_bf16 v[40:55], v[120:123], a[60:63], v[40:55]
    ds_read_b64_tr_b16 v[120:121], v13 offset:4096
    ds_read_b64_tr_b16 v[122:123], v13 offset:4608
    s_add_u32 m0, s1, 8448
    s_add_u32 s43, s52, 18432
    buffer_load_dwordx4 v21, s[28:31], s43 offen sc1 lds
    v_mfma_f32_32x32x16_bf16 v[56:71], v[124:127], a[60:63], v[56:71]
    ds_read_b64_tr_b16 v[124:125], v13 offset:12288
    ds_read_b64_tr_b16 v[126:127], v13 offset:12800
    s_add_u32 m0, s51, 32768
    s_add_u32 s64, s53, 42240
    buffer_load_dwordx4 v8, s[16:19], s64 offen offset:2048 lds
    s_waitcnt lgkmcnt(9)
    v_mfma_f32_32x32x16_bf16 v[40:55], v[32:35], a[64:67], v[40:55]
    ds_read_b64_tr_b16 v[32:33], v13 offset:6144
    ds_read_b64_tr_b16 v[34:35], v13 offset:6656
    ds_read_b32 v20, v0 offset:0
    v_mfma_f32_32x32x16_bf16 v[56:71], v[36:39], a[64:67], v[56:71]
    ds_read_b64_tr_b16 v[36:37], v13 offset:14336
    ds_read_b64_tr_b16 v[38:39], v13 offset:14848
    s_add_u32 m0, s51, 32768
    s_nop 0
    buffer_load_dwordx4 v9, s[16:19], s64 offen offset:3072 lds
    s_waitcnt lgkmcnt(9)
    v_mfma_f32_32x32x16_bf16 v[40:55], v[112:115], a[68:71], v[40:55]
    s_waitcnt lgkmcnt(2)
    s_setprio 3
    v_cmp_gt_u32 vcc, s56, v20
    s_setprio 0
    s_cbranch_vccnz L_chk39
L_chk39_x:
    s_add_u32 s56, s56, 1
    ds_read_b64_tr_b16 v[112:113], v13 offset:16384
    ds_read_b64_tr_b16 v[114:115], v13 offset:16896
    s_waitcnt vmcnt(12)
    ds_add_u32 v18, v19 offset:512
    v_mfma_f32_32x32x16_bf16 v[56:71], v[116:119], a[68:71], v[56:71]
    ds_read_b64_tr_b16 v[116:117], v13 offset:24576
    ds_read_b64_tr_b16 v[118:119], v13 offset:25088
    s_add_u32 m0, s51, 49152
    s_add_u32 s64, s53, 176384
    buffer_load_dwordx4 v8, s[16:19], s64 offen lds
    v_mfma_f32_32x32x16_bf16 v[40:55], v[120:123], a[72:75], v[40:55]
    ds_read_b64_tr_b16 v[120:121], v13 offset:18432
    ds_read_b64_tr_b16 v[122:123], v13 offset:18944
    s_waitcnt vmcnt(11)
    ds_add_u32 v18, v19
    v_mfma_f32_32x32x16_bf16 v[56:71], v[124:127], a[72:75], v[56:71]
    ds_read_b64_tr_b16 v[124:125], v13 offset:26624
    ds_read_b64_tr_b16 v[126:127], v13 offset:27136
    s_add_u32 m0, s51, 49152
    s_nop 0
    buffer_load_dwordx4 v9, s[16:19], s64 offen offset:1024 lds
    s_waitcnt lgkmcnt(10)
    v_mfma_f32_32x32x16_bf16 v[40:55], v[32:35], a[76:79], v[40:55]
    ds_read_b64_tr_b16 v[32:33], v13 offset:20480
    ds_read_b64_tr_b16 v[34:35], v13 offset:20992
    s_add_u32 m0, s1, 9504
    s_add_u32 s43, s52, 19456
    buffer_load_dwordx4 v21, s[28:31], s43 offen sc1 lds
    v_mfma_f32_32x32x16_bf16 v[56:71], v[36:39], a[76:79], v[56:71]
    ds_read_b64_tr_b16 v[36:37], v13 offset:28672
    ds_read_b64_tr_b16 v[38:39], v13 offset:29184
    s_add_u32 m0, s51, 49152
    s_add_u32 s64, s53, 218368
    buffer_load_dwordx4 v8, s[16:19], s64 offen offset:2048 lds
    s_waitcnt lgkmcnt(9)
    v_mfma_f32_32x32x16_bf16 v[40:55], v[112:115], a[80:83], v[40:55]
    ds_read_b64_tr_b16 v[112:113], v13 offset:22528
    ds_read_b64_tr_b16 v[114:115], v13 offset:23040
    ds_read_b32 v20, v0 offset:0
    s_lshr_b32 s4, s2, 5
    s_lshl_b32 s4, s4, 1
    s_add_u32 s4, s4, s49
    s_lshl_b32 s4, s4, 1
    s_add_u32 s4, s4, s50
    s_and_b32 s5, s2, 7
    s_lshl_b32 s5, s5, 2
    s_bfe_u32 s6, s2, 0x20003
    s_add_u32 s5, s5, s6
    s_lshl_b32 s6, s4, 16
    s_lshl_b32 s7, s5, 10
    s_add_u32 s6, s6, s7
    s_add_u32 s6, s6, 6291456
    s_add_u32 s7, s6, 32768
    buffer_store_dwordx4 v[136:139], v21, s[28:31], s6 offen sc1
    buffer_store_dwordx4 v[136:139], v21, s[28:31], s7 offen sc1
    v_mfma_f32_32x32x16_bf16 v[56:71], v[116:119], a[80:83], v[56:71]
    ds_read_b64_tr_b16 v[116:117], v13 offset:30720
    ds_read_b64_tr_b16 v[118:119], v13 offset:31232
    s_add_u32 m0, s51, 49152
    s_nop 0
    buffer_load_dwordx4 v9, s[16:19], s64 offen offset:3072 lds
    s_waitcnt lgkmcnt(9)
    v_mfma_f32_32x32x16_bf16 v[40:55], v[120:123], a[84:87], v[40:55]
    s_waitcnt lgkmcnt(2)
    s_setprio 3
    v_cmp_gt_u32 vcc, s56, v20
    s_setprio 0
    s_cbranch_vccnz L_chk40
L_chk40_x:
    s_add_u32 s56, s56, 1
    ds_read_b64_tr_b16 v[120:121], v13 offset:32768
    ds_read_b64_tr_b16 v[122:123], v13 offset:33280
    s_waitcnt vmcnt(14)
    ds_add_u32 v18, v19 offset:512
    ds_read_b32 v25, v0 offset:1024
    v_mfma_f32_32x32x16_bf16 v[56:71], v[124:127], a[84:87], v[56:71]
    ds_read_b64_tr_b16 v[124:125], v13 offset:40960
    ds_read_b64_tr_b16 v[126:127], v13 offset:41472
    s_add_u32 m0, s51, 65536
    s_add_u32 s64, s53, 352512
    buffer_load_dwordx4 v8, s[16:19], s64 offen lds
    v_mfma_f32_32x32x16_bf16 v[40:55], v[32:35], a[88:91], v[40:55]
    ds_read_b64_tr_b16 v[32:33], v13 offset:34816
    ds_read_b64_tr_b16 v[34:35], v13 offset:35328
    s_waitcnt vmcnt(13)
    ds_add_u32 v18, v19
    s_waitcnt lgkmcnt(5)
    s_setprio 3
    v_cmp_gt_u32 vcc, 21, v25
    s_setprio 0
    s_cbranch_vccnz L_chk41
L_chk41_x:
    v_mfma_f32_32x32x16_bf16 v[56:71], v[36:39], a[88:91], v[56:71]
    ds_read_b64_tr_b16 v[36:37], v13 offset:43008
    ds_read_b64_tr_b16 v[38:39], v13 offset:43520
    s_add_u32 m0, s51, 65536
    s_nop 0
    buffer_load_dwordx4 v9, s[16:19], s64 offen offset:1024 lds
    v_mfma_f32_32x32x16_bf16 v[40:55], v[112:115], a[92:95], v[40:55]
    ds_read_b64_tr_b16 v[112:113], v13 offset:36864
    ds_read_b64_tr_b16 v[114:115], v13 offset:37376
    s_add_u32 m0, s1, 0
    s_add_u32 s43, s52, 20480
    buffer_load_dwordx4 v21, s[28:31], s43 offen sc1 lds
    v_mfma_f32_32x32x16_bf16 v[56:71], v[116:119], a[92:95], v[56:71]
    ds_read_b64_tr_b16 v[116:117], v13 offset:45056
    ds_read_b64_tr_b16 v[118:119], v13 offset:45568
    s_add_u32 m0, s51, 65536
    s_add_u32 s64, s53, 394496
    buffer_load_dwordx4 v8, s[16:19], s64 offen offset:2048 lds
    s_waitcnt lgkmcnt(9)
    v_mfma_f32_32x32x16_bf16 v[40:55], v[120:123], a[96:99], v[40:55]
    ds_read_b64_tr_b16 v[120:121], v13 offset:38912
    ds_read_b64_tr_b16 v[122:123], v13 offset:39424
    ds_read_b32 v20, v0 offset:0
    v_mfma_f32_32x32x16_bf16 v[56:71], v[124:127], a[96:99], v[56:71]
    ds_read_b64_tr_b16 v[124:125], v13 offset:47104
    ds_read_b64_tr_b16 v[126:127], v13 offset:47616
    s_add_u32 m0, s51, 65536
    s_nop 0
    buffer_load_dwordx4 v9, s[16:19], s64 offen offset:3072 lds
    s_waitcnt lgkmcnt(9)
    v_mfma_f32_32x32x16_bf16 v[40:55], v[32:35], a[100:103], v[40:55]
    s_waitcnt lgkmcnt(2)
    s_setprio 3
    v_cmp_gt_u32 vcc, s56, v20
    s_setprio 0
    s_cbranch_vccnz L_chk42
L_chk42_x:
    s_add_u32 s56, s56, 1
    ds_read_b64_tr_b16 v[32:33], v13 offset:49152
    ds_read_b64_tr_b16 v[34:35], v13 offset:49664
    s_waitcnt vmcnt(14)
    ds_add_u32 v18, v19 offset:512
    v_mfma_f32_32x32x16_bf16 v[56:71], v[36:39], a[100:103], v[56:71]
    ds_read_b64_tr_b16 v[36:37], v13 offset:57344
    ds_read_b64_tr_b16 v[38:39], v13 offset:57856
    s_add_u32 m0, s51, 81920
    s_add_u32 s64, s53, 528640
    buffer_load_dwordx4 v8, s[16:19], s64 offen lds
    v_mfma_f32_32x32x16_bf16 v[40:55], v[112:115], a[104:107], v[40:55]
    ds_read_b64_tr_b16 v[112:113], v13 offset:51200
    ds_read_b64_tr_b16 v[114:115], v13 offset:51712
    s_waitcnt vmcnt(13)
    ds_add_u32 v18, v19
    v_mfma_f32_32x32x16_bf16 v[56:71], v[116:119], a[104:107], v[56:71]
    ds_read_b64_tr_b16 v[116:117], v13 offset:59392
    ds_read_b64_tr_b16 v[118:119], v13 offset:59904
    s_add_u32 m0, s51, 81920
    s_nop 0
    buffer_load_dwordx4 v9, s[16:19], s64 offen offset:1024 lds
    s_waitcnt lgkmcnt(10)
    v_mfma_f32_32x32x16_bf16 v[40:55], v[120:123], a[108:111], v[40:55]
    ds_read_b64_tr_b16 v[120:121], v13 offset:53248
    ds_read_b64_tr_b16 v[122:123], v13 offset:53760
    s_add_u32 m0, s1, 1056
    s_add_u32 s43, s52, 21504
    buffer_load_dwordx4 v21, s[28:31], s43 offen sc1 lds
    v_mfma_f32_32x32x16_bf16 v[56:71], v[124:127], a[108:111], v[56:71]
    ds_read_b64_tr_b16 v[124:125], v13 offset:61440
    ds_read_b64_tr_b16 v[126:127], v13 offset:61952
    s_add_u32 m0, s51, 81920
    s_add_u32 s64, s53, 570624
    buffer_load_dwordx4 v8, s[16:19], s64 offen offset:2048 lds
    s_waitcnt lgkmcnt(9)
    v_mfma_f32_32x32x16_bf16 v[40:55], v[32:35], v[96:99], v[40:55]
    ds_read_b64_tr_b16 v[32:33], v13 offset:55296
    ds_read_b64_tr_b16 v[34:35], v13 offset:55808
    ds_read_b32 v20, v0 offset:0
    s_waitcnt vmcnt(10)
    s_lshl_b32 s6, s4, 12
    s_lshl_b32 s7, s5, 7
    s_add_u32 s6, s6, s7
    s_add_u32 s6, s6, 25821184
    s_mov_b64 exec, 1
    buffer_store_dword v22, v4, s[28:31], s6 offen sc1
    s_mov_b64 exec, -1
    v_mfma_f32_32x32x16_bf16 v[56:71], v[36:39], v[96:99], v[56:71]
    ds_read_b64_tr_b16 v[36:37], v13 offset:63488
    ds_read_b64_tr_b16 v[38:39], v13 offset:64000
    s_add_u32 m0, s51, 81920
    s_nop 0
    buffer_load_dwordx4 v9, s[16:19], s64 offen offset:3072 lds
    s_waitcnt lgkmcnt(9)
    v_mfma_f32_32x32x16_bf16 v[40:55], v[112:115], v[100:103], v[40:55]
    s_waitcnt lgkmcnt(2)
    s_setprio 3
    v_cmp_gt_u32 vcc, s56, v20
    s_setprio 0
    s_cbranch_vccnz L_chk43
L_chk43_x:
    s_add_u32 s56, s56, 1
    ds_read_b64_tr_b16 v[112:113], v12 offset:32768
    ds_read_b64_tr_b16 v[114:115], v12 offset:33280
    ds_add_u32 v18, v19 offset:512
    ds_read_b32 v25, v0 offset:1024
    v_mfma_f32_32x32x16_bf16 v[56:71], v[116:119], v[100:103], v[56:71]
    ds_read_b64_tr_b16 v[116:117], v12 offset:40960
    ds_read_b64_tr_b16 v[118:119], v12 offset:41472
    s_add_u32 m0, s51, 98304
    s_add_u32 s64, s53, 704768
    buffer_load_dwordx4 v8, s[16:19], s64 offen lds
    v_mfma_f32_32x32x16_bf16 v[40:55], v[120:123], v[104:107], v[40:55]
    ds_read_b64_tr_b16 v[120:121], v12 offset:34816
    ds_read_b64_tr_b16 v[122:123], v12 offset:35328
    s_waitcnt vmcnt(12)
    ds_add_u32 v18, v19
    s_waitcnt lgkmcnt(5)
    s_setprio 3
    v_cmp_gt_u32 vcc, 22, v25
    s_setprio 0
    s_cbranch_vccnz L_chk44
L_chk44_x:
    v_mfma_f32_32x32x16_bf16 v[56:71], v[124:127], v[104:107], v[56:71]
    ds_read_b64_tr_b16 v[124:125], v12 offset:43008
    ds_read_b64_tr_b16 v[126:127], v12 offset:43520
    s_add_u32 m0, s51, 98304
    s_nop 0
    buffer_load_dwordx4 v9, s[16:19], s64 offen offset:1024 lds
    v_mfma_f32_32x32x16_bf16 v[40:55], v[32:35], v[108:111], v[40:55]
    ds_read_b64_tr_b16 v[32:33], v12 offset:36864
    ds_read_b64_tr_b16 v[34:35], v12 offset:37376
    s_add_u32 m0, s1, 2112
    s_add_u32 s43, s52, 22528
    buffer_load_dwordx4 v21, s[28:31], s43 offen sc1 lds
    v_mfma_f32_32x32x16_bf16 v[56:71], v[36:39], v[108:111], v[56:71]
    ds_read_b64_tr_b16 v[36:37], v12 offset:45056
    ds_read_b64_tr_b16 v[38:39], v12 offset:45568
    s_add_u32 m0, s51, 98304
    s_add_u32 s64, s53, 746752
    buffer_load_dwordx4 v8, s[16:19], s64 offen offset:2048 lds
    s_setprio 3
    s_nop 9
    v_pk_mul_f32 v[72:73], v[40:41], v[40:41]
    v_pk_mul_f32 v[74:75], v[42:43], v[42:43]
    v_pk_mul_f32 v[76:77], v[44:45], v[44:45]
    v_pk_mul_f32 v[78:79], v[46:47], v[46:47]
    v_pk_mul_f32 v[80:81], v[48:49], v[48:49]
    v_pk_mul_f32 v[82:83], v[50:51], v[50:51]
    v_pk_mul_f32 v[84:85], v[52:53], v[52:53]
    v_pk_mul_f32 v[86:87], v[54:55], v[54:55]
    v_pk_fma_f32 v[72:73], v[72:73], s[62:63], v[2:3]
    v_pk_fma_f32 v[74:75], v[74:75], s[62:63], v[2:3]
    v_pk_fma_f32 v[76:77], v[76:77], s[62:63], v[2:3]
    v_pk_fma_f32 v[78:79], v[78:79], s[62:63], v[2:3]
    v_pk_fma_f32 v[80:81], v[80:81], s[62:63], v[2:3]
    v_pk_fma_f32 v[82:83], v[82:83], s[62:63], v[2:3]
    v_pk_fma_f32 v[84:85], v[84:85], s[62:63], v[2:3]
    v_pk_fma_f32 v[86:87], v[86:87], s[62:63], v[2:3]
    v_pk_mul_f32 v[88:89], v[56:57], v[40:41]
    v_pk_mul_f32 v[90:91], v[58:59], v[42:43]
    v_pk_mul_f32 v[92:93], v[60:61], v[44:45]
    v_pk_mul_f32 v[94:95], v[62:63], v[46:47]
    v_pk_mul_f32 v[128:129], v[64:65], v[48:49]
    v_pk_mul_f32 v[130:131], v[66:67], v[50:51]
    v_pk_mul_f32 v[132:133], v[68:69], v[52:53]
    v_pk_mul_f32 v[134:135], v[70:71], v[54:55]
    v_pk_mul_f32 v[72:73], v[72:73], v[40:41]
    v_pk_mul_f32 v[74:75], v[74:75], v[42:43]
    v_pk_mul_f32 v[76:77], v[76:77], v[44:45]
    v_pk_mul_f32 v[78:79], v[78:79], v[46:47]
    v_pk_mul_f32 v[80:81], v[80:81], v[48:49]
    v_pk_mul_f32 v[82:83], v[82:83], v[50:51]
    v_pk_mul_f32 v[84:85], v[84:85], v[52:53]
    v_pk_mul_f32 v[86:87], v[86:87], v[54:55]
    s_setprio 0
    v_mfma_f32_32x32x16_bf16 v[40:55], v[112:115], a[0:3], 0
    s_setprio 3
    v_exp_f32 v72, v72
    v_exp_f32 v73, v73
    v_exp_f32 v74, v74
    v_exp_f32 v75, v75
    s_setprio 0
    ds_read_b64_tr_b16 v[112:113], v12 offset:38912
    ds_read_b64_tr_b16 v[114:115], v12 offset:39424
    ds_read_b32 v20, v0 offset:0
    s_waitcnt lgkmcnt(12)
    v_mfma_f32_32x32x16_bf16 v[56:71], v[116:119], a[0:3], 0
    s_setprio 3
    v_exp_f32 v76, v76
    v_exp_f32 v77, v77
    v_exp_f32 v78, v78
    v_exp_f32 v79, v79
    s_setprio 0
    ds_read_b64_tr_b16 v[116:117], v12 offset:47104
    ds_read_b64_tr_b16 v[118:119], v12 offset:47616
    s_add_u32 m0, s51, 98304
    s_nop 0
    buffer_load_dwordx4 v9, s[16:19], s64 offen offset:3072 lds
    s_waitcnt lgkmcnt(12)
    v_mfma_f32_32x32x16_bf16 v[40:55], v[120:123], a[4:7], v[40:55]
    s_setprio 3
    v_exp_f32 v80, v80
    v_exp_f32 v81, v81
    v_exp_f32 v82, v82
    v_exp_f32 v83, v83
    s_setprio 0
    s_waitcnt lgkmcnt(2)
    s_setprio 3
    v_cmp_gt_u32 vcc, s56, v20
    s_setprio 0
    s_cbranch_vccnz L_chk45
L_chk45_x:
    s_add_u32 s56, s56, 1
    ds_read_b64_tr_b16 v[120:121], v12 offset:49152
    ds_read_b64_tr_b16 v[122:123], v12 offset:49664
    s_waitcnt vmcnt(13)
    ds_add_u32 v18, v19 offset:512
    v_mfma_f32_32x32x16_bf16 v[56:71], v[124:127], a[4:7], v[56:71]
    s_setprio 3
    v_exp_f32 v84, v84
    v_exp_f32 v85, v85
    v_exp_f32 v86, v86
    v_exp_f32 v87, v87
    s_setprio 0
    ds_read_b64_tr_b16 v[124:125], v12 offset:57344
    ds_read_b64_tr_b16 v[126:127], v12 offset:57856
    s_add_u32 m0, s51, 114688
    s_add_u32 s64, s53, 880896
    buffer_load_dwordx4 v8, s[16:19], s64 offen lds
    v_mfma_f32_32x32x16_bf16 v[40:55], v[32:35], a[8:11], v[40:55]
    s_setprio 3
    v_pk_add_f32 v[72:73], v[72:73], 1.0 op_sel_hi:[1,0]
    v_pk_add_f32 v[74:75], v[74:75], 1.0 op_sel_hi:[1,0]
    v_pk_add_f32 v[76:77], v[76:77], 1.0 op_sel_hi:[1,0]
    v_pk_add_f32 v[78:79], v[78:79], 1.0 op_sel_hi:[1,0]
    v_pk_add_f32 v[80:81], v[80:81], 1.0 op_sel_hi:[1,0]
    v_pk_add_f32 v[82:83], v[82:83], 1.0 op_sel_hi:[1,0]
    v_pk_add_f32 v[84:85], v[84:85], 1.0 op_sel_hi:[1,0]
    v_pk_add_f32 v[86:87], v[86:87], 1.0 op_sel_hi:[1,0]
    s_setprio 0
    ds_read_b64_tr_b16 v[32:33], v12 offset:51200
    ds_read_b64_tr_b16 v[34:35], v12 offset:51712
    s_waitcnt vmcnt(12)
    ds_add_u32 v18, v19
    v_mfma_f32_32x32x16_bf16 v[56:71], v[36:39], a[8:11], v[56:71]
    s_setprio 3
    v_rcp_f32 v72, v72
    v_rcp_f32 v73, v73
    v_rcp_f32 v74, v74
    v_rcp_f32 v75, v75
    s_setprio 0
    ds_read_b64_tr_b16 v[36:37], v12 offset:59392
    ds_read_b64_tr_b16 v[38:39], v12 offset:59904
    s_add_u32 m0, s51, 114688
    s_nop 0
    buffer_load_dwordx4 v9, s[16:19], s64 offen offset:1024 lds
    v_mfma_f32_32x32x16_bf16 v[40:55], v[112:115], a[12:15], v[40:55]
    s_setprio 3
    v_rcp_f32 v76, v76
    v_rcp_f32 v77, v77
    v_rcp_f32 v78, v78
    v_rcp_f32 v79, v79
    s_setprio 0
    ds_read_b64_tr_b16 v[112:113], v12 offset:53248
    ds_read_b64_tr_b16 v[114:115], v12 offset:53760
    s_add_u32 m0, s1, 3168
    s_add_u32 s43, s52, 23552
    buffer_load_dwordx4 v21, s[28:31], s43 offen sc1 lds
    s_waitcnt lgkmcnt(12)
    v_mfma_f32_32x32x16_bf16 v[56:71], v[116:119], a[12:15], v[56:71]
    s_setprio 3
    v_rcp_f32 v80, v80
    v_rcp_f32 v81, v81
    v_rcp_f32 v82, v82
    v_rcp_f32 v83, v83
    s_setprio 0
    ds_read_b64_tr_b16 v[116:117], v12 offset:61440
    ds_read_b64_tr_b16 v[118:119], v12 offset:61952
    s_add_u32 m0, s51, 114688
    s_add_u32 s64, s53, 922880
    buffer_load_dwordx4 v8, s[16:19], s64 offen offset:2048 lds
    s_waitcnt lgkmcnt(12)
    v_mfma_f32_32x32x16_bf16 v[40:55], v[120:123], a[16:19], v[40:55]
    s_setprio 3
    v_rcp_f32 v84, v84
    v_rcp_f32 v85, v85
    v_rcp_f32 v86, v86
    v_rcp_f32 v87, v87
    s_setprio 0
    ds_read_b64_tr_b16 v[120:121], v12 offset:55296
    ds_read_b64_tr_b16 v[122:123], v12 offset:55808
    ds_read_b32 v20, v0 offset:0
    s_waitcnt lgkmcnt(12)
    v_mfma_f32_32x32x16_bf16 v[56:71], v[124:127], a[16:19], v[56:71]
    s_setprio 3
    v_pk_mul_f32 v[88:89], v[88:89], v[72:73]
    v_pk_mul_f32 v[90:91], v[90:91], v[74:75]
    v_pk_mul_f32 v[92:93], v[92:93], v[76:77]
    v_pk_mul_f32 v[94:95], v[94:95], v[78:79]
    v_pk_mul_f32 v[128:129], v[128:129], v[80:81]
    v_pk_mul_f32 v[130:131], v[130:131], v[82:83]
    v_pk_mul_f32 v[132:133], v[132:133], v[84:85]
    v_pk_mul_f32 v[134:135], v[134:135], v[86:87]
    s_setprio 0
    ds_read_b64_tr_b16 v[124:125], v12 offset:63488
    ds_read_b64_tr_b16 v[126:127], v12 offset:64000
    s_add_u32 m0, s51, 114688
    s_nop 0
    buffer_load_dwordx4 v9, s[16:19], s64 offen offset:3072 lds
    s_waitcnt lgkmcnt(12)
    v_mfma_f32_32x32x16_bf16 v[40:55], v[32:35], a[20:23], v[40:55]
    s_setprio 3
    v_cvt_pk_bf16_f32 v72, v88, v89
    v_cvt_pk_bf16_f32 v73, v90, v91
    v_cvt_pk_bf16_f32 v74, v92, v93
    v_cvt_pk_bf16_f32 v75, v94, v95
    v_cvt_pk_bf16_f32 v76, v128, v129
    v_cvt_pk_bf16_f32 v77, v130, v131
    v_cvt_pk_bf16_f32 v78, v132, v133
    v_cvt_pk_bf16_f32 v79, v134, v135
    s_setprio 0
    s_waitcnt lgkmcnt(2)
    s_setprio 3
    v_cmp_gt_u32 vcc, s56, v20
    s_setprio 0
    s_cbranch_vccnz L_chk46
L_chk46_x:
    s_add_u32 s56, s56, 1
    ds_read_b64_tr_b16 v[32:33], v13 offset:0
    ds_read_b64_tr_b16 v[34:35], v13 offset:512
    s_waitcnt vmcnt(13)
    ds_add_u32 v18, v19 offset:512
    ds_read_b32 v25, v0 offset:1024
    v_mfma_f32_32x32x16_bf16 v[56:71], v[36:39], a[20:23], v[56:71]
    s_add_u32 s43, s58, 4096
    buffer_store_dwordx4 v[72:75], v21, s[28:31], s43 offen sc1
    buffer_store_dwordx4 v[76:79], v21, s[28:31], s43 offen offset:1024 sc1
L_hskip47:
    ds_read_b64_tr_b16 v[36:37], v13 offset:8192
    ds_read_b64_tr_b16 v[38:39], v13 offset:8704
    s_add_u32 m0, s51, 32768
    s_add_u32 s64, s53, 1057024
    buffer_load_dwordx4 v8, s[16:19], s64 offen lds
    v_mfma_f32_32x32x16_bf16 v[40:55], v[112:115], a[24:27], v[40:55]
    ds_read_b64_tr_b16 v[112:113], v13 offset:2048
    ds_read_b64_tr_b16 v[114:115], v13 offset:2560
    s_waitcnt vmcnt(11)
    ds_add_u32 v18, v19
    s_waitcnt lgkmcnt(5)
    s_setprio 3
    v_cmp_gt_u32 vcc, 23, v25
    s_setprio 0
    s_cbranch_vccnz L_chk48
L_chk48_x:
    v_mfma_f32_32x32x16_bf16 v[56:71], v[116:119], a[24:27], v[56:71]
    ds_read_b64_tr_b16 v[116:117], v13 offset:10240
    ds_read_b64_tr_b16 v[118:119], v13 offset:10752
    s_add_u32 m0, s51, 32768
    s_nop 0
    buffer_load_dwordx4 v9, s[16:19], s64 offen offset:1024 lds
    v_mfma_f32_32x32x16_bf16 v[40:55], v[120:123], a[28:31], v[40:55]
    ds_read_b64_tr_b16 v[120:121], v13 offset:4096
    ds_read_b64_tr_b16 v[122:123], v13 offset:4608
    s_add_u32 m0, s1, 4224
    s_add_u32 s43, s52, 24576
    buffer_load_dwordx4 v21, s[28:31], s43 offen sc1 lds
    v_mfma_f32_32x32x16_bf16 v[56:71], v[124:127], a[28:31], v[56:71]
    ds_read_b64_tr_b16 v[124:125], v13 offset:12288
    ds_read_b64_tr_b16 v[126:127], v13 offset:12800
    s_add_u32 m0, s51, 32768
    s_add_u32 s64, s53, 1099008
    buffer_load_dwordx4 v8, s[16:19], s64 offen offset:2048 lds
    s_waitcnt lgkmcnt(9)
    v_mfma_f32_32x32x16_bf16 v[40:55], v[32:35], a[32:35], v[40:55]
    ds_read_b64_tr_b16 v[32:33], v13 offset:6144
    ds_read_b64_tr_b16 v[34:35], v13 offset:6656
    ds_read_b32 v20, v0 offset:0
    s_lshl_b32 s45, s41, 12
    s_lshl_b32 s43, s48, 10
    s_add_u32 s45, s45, s43
    s_add_u32 s45, s45, 25821184
    s_mov_b64 exec, 0xff
    buffer_load_dword v5, v23, s[28:31], s45 offen sc1
    s_mov_b64 exec, -1
    v_mfma_f32_32x32x16_bf16 v[56:71], v[36:39], a[32:35], v[56:71]
    ds_read_b64_tr_b16 v[36:37], v13 offset:14336
    ds_read_b64_tr_b16 v[38:39], v13 offset:14848
    s_add_u32 m0, s51, 32768
    s_nop 0
    buffer_load_dwordx4 v9, s[16:19], s64 offen offset:3072 lds
    s_waitcnt lgkmcnt(9)
    v_mfma_f32_32x32x16_bf16 v[40:55], v[112:115], a[36:39], v[40:55]
    s_waitcnt lgkmcnt(2)
    s_setprio 3
    v_cmp_gt_u32 vcc, s56, v20
    s_setprio 0
    s_cbranch_vccnz L_chk49
L_chk49_x:
    s_add_u32 s56, s56, 1
    ds_read_b64_tr_b16 v[112:113], v13 offset:16384
    ds_read_b64_tr_b16 v[114:115], v13 offset:16896
    s_waitcnt vmcnt(13)
    ds_add_u32 v18, v19 offset:512
    v_mfma_f32_32x32x16_bf16 v[56:71], v[116:119], a[36:39], v[56:71]
    ds_read_b64_tr_b16 v[116:117], v13 offset:24576
    ds_read_b64_tr_b16 v[118:119], v13 offset:25088
    s_add_u32 m0, s51, 49152
    s_add_u32 s64, s53, 1233152
    buffer_load_dwordx4 v8, s[16:19], s64 offen lds
    v_mfma_f32_32x32x16_bf16 v[40:55], v[120:123], a[40:43], v[40:55]
    ds_read_b64_tr_b16 v[120:121], v13 offset:18432
    ds_read_b64_tr_b16 v[122:123], v13 offset:18944
    s_waitcnt vmcnt(12)
    ds_add_u32 v18, v19
    v_mfma_f32_32x32x16_bf16 v[56:71], v[124:127], a[40:43], v[56:71]
    ds_read_b64_tr_b16 v[124:125], v13 offset:26624
    ds_read_b64_tr_b16 v[126:127], v13 offset:27136
    s_add_u32 m0, s51, 49152
    s_nop 0
    buffer_load_dwordx4 v9, s[16:19], s64 offen offset:1024 lds
    s_waitcnt lgkmcnt(10)
    v_mfma_f32_32x32x16_bf16 v[40:55], v[32:35], a[44:47], v[40:55]
    ds_read_b64_tr_b16 v[32:33], v13 offset:20480
    ds_read_b64_tr_b16 v[34:35], v13 offset:20992
    s_add_u32 m0, s1, 5280
    s_add_u32 s43, s52, 25600
    buffer_load_dwordx4 v21, s[28:31], s43 offen sc1 lds
    v_mfma_f32_32x32x16_bf16 v[56:71], v[36:39], a[44:47], v[56:71]
    ds_read_b64_tr_b16 v[36:37], v13 offset:28672
    ds_read_b64_tr_b16 v[38:39], v13 offset:29184
    s_add_u32 m0, s51, 49152
    s_add_u32 s64, s53, 1275136
    buffer_load_dwordx4 v8, s[16:19], s64 offen offset:2048 lds
    s_waitcnt lgkmcnt(9)
    v_mfma_f32_32x32x16_bf16 v[40:55], v[112:115], a[48:51], v[40:55]
    ds_read_b64_tr_b16 v[112:113], v13 offset:22528
    ds_read_b64_tr_b16 v[114:115], v13 offset:23040
    ds_read_b32 v20, v0 offset:0
    s_waitcnt vmcnt(10)
    s_add_u32 s43, s61, 4096
    s_mov_b64 exec, 1
    buffer_store_dword v22, v4, s[28:31], s43 offen sc1
    s_mov_b64 exec, -1
    v_mfma_f32_32x32x16_bf16 v[56:71], v[116:119], a[48:51], v[56:71]
    ds_read_b64_tr_b16 v[116:117], v13 offset:30720
    ds_read_b64_tr_b16 v[118:119], v13 offset:31232
    s_add_u32 m0, s51, 49152
    s_nop 0
    buffer_load_dwordx4 v9, s[16:19], s64 offen offset:3072 lds
    s_waitcnt lgkmcnt(9)
    v_mfma_f32_32x32x16_bf16 v[40:55], v[120:123], a[52:55], v[40:55]
    s_waitcnt lgkmcnt(2)
    s_setprio 3
    v_cmp_gt_u32 vcc, s56, v20
    s_setprio 0
    s_cbranch_vccnz L_chk50
L_chk50_x:
    s_add_u32 s56, s56, 1
    ds_read_b64_tr_b16 v[120:121], v13 offset:32768
    ds_read_b64_tr_b16 v[122:123], v13 offset:33280
    ds_add_u32 v18, v19 offset:512
    ds_read_b32 v25, v0 offset:1024
    v_mfma_f32_32x32x16_bf16 v[56:71], v[124:127], a[52:55], v[56:71]
    ds_read_b64_tr_b16 v[124:125], v13 offset:40960
    ds_read_b64_tr_b16 v[126:127], v13 offset:41472
    s_add_u32 m0, s51, 65536
    s_add_u32 s64, s54, 0
    buffer_load_dwordx4 v10, s[20:23], s64 offen lds
    v_mfma_f32_32x32x16_bf16 v[40:55], v[32:35], a[56:59], v[40:55]
    ds_read_b64_tr_b16 v[32:33], v13 offset:34816
    ds_read_b64_tr_b16 v[34:35], v13 offset:35328
    ds_add_u32 v18, v19
    s_waitcnt lgkmcnt(5)
    s_setprio 3
    v_cmp_gt_u32 vcc, 24, v25
    s_setprio 0
    s_cbranch_vccnz L_chk51
L_chk51_x:
    s_waitcnt vmcnt(7)
    s_setprio 3
    v_cmp_ne_u32 vcc, s46, v5
    s_setprio 0
    s_and_b32 vcc_lo, vcc_lo, 0xff
    s_cbranch_scc1 L_fo_s
L_fo_b:
    v_mfma_f32_32x32x16_bf16 v[56:71], v[36:39], a[56:59], v[56:71]
    ds_read_b64_tr_b16 v[36:37], v13 offset:43008
    ds_read_b64_tr_b16 v[38:39], v13 offset:43520
    s_add_u32 m0, s51, 65536
    s_nop 0
    buffer_load_dwordx4 v11, s[20:23], s64 offen offset:1024 lds
    v_mfma_f32_32x32x16_bf16 v[40:55], v[112:115], a[60:63], v[40:55]
    ds_read_b64_tr_b16 v[112:113], v13 offset:36864
    ds_read_b64_tr_b16 v[114:115], v13 offset:37376
    s_add_u32 m0, s1, 6336
    s_add_u32 s43, s52, 26624
    buffer_load_dwordx4 v21, s[28:31], s43 offen sc1 lds
    v_mfma_f32_32x32x16_bf16 v[56:71], v[116:119], a[60:63], v[56:71]
    ds_read_b64_tr_b16 v[116:117], v13 offset:45056
    ds_read_b64_tr_b16 v[118:119], v13 offset:45568
    s_add_u32 m0, s51, 65536
    s_add_u32 s64, s54, 194560
    buffer_load_dwordx4 v10, s[20:23], s64 offen offset:2048 lds
    s_waitcnt lgkmcnt(9)
    v_mfma_f32_32x32x16_bf16 v[40:55], v[120:123], a[64:67], v[40:55]
    ds_read_b64_tr_b16 v[120:121], v13 offset:38912
    ds_read_b64_tr_b16 v[122:123], v13 offset:39424
    ds_read_b32 v20, v0 offset:0
    v_mfma_f32_32x32x16_bf16 v[56:71], v[124:127], a[64:67], v[56:71]
    ds_read_b64_tr_b16 v[124:125], v13 offset:47104
    ds_read_b64_tr_b16 v[126:127], v13 offset:47616
    s_add_u32 m0, s51, 65536
    s_nop 0
    buffer_load_dwordx4 v11, s[20:23], s64 offen offset:3072 lds
    s_waitcnt lgkmcnt(9)
    v_mfma_f32_32x32x16_bf16 v[40:55], v[32:35], a[68:71], v[40:55]
    s_waitcnt lgkmcnt(2)
    s_setprio 3
    v_cmp_gt_u32 vcc, s56, v20
    s_setprio 0
    s_cbranch_vccnz L_chk52
L_chk52_x:
    s_add_u32 s56, s56, 1
    ds_read_b64_tr_b16 v[32:33], v13 offset:49152
    ds_read_b64_tr_b16 v[34:35], v13 offset:49664
    ds_add_u32 v18, v19 offset:512
    v_mfma_f32_32x32x16_bf16 v[56:71], v[36:39], a[68:71], v[56:71]
    ds_read_b64_tr_b16 v[36:37], v13 offset:57344
    ds_read_b64_tr_b16 v[38:39], v13 offset:57856
    s_add_u32 m0, s51, 81920
    s_add_u32 s64, s54, 393216
    buffer_load_dwordx4 v10, s[20:23], s64 offen lds
    v_mfma_f32_32x32x16_bf16 v[40:55], v[112:115], a[72:75], v[40:55]
    ds_read_b64_tr_b16 v[112:113], v13 offset:51200
    ds_read_b64_tr_b16 v[114:115], v13 offset:51712
    s_waitcnt vmcnt(11)
    ds_add_u32 v18, v19
    v_mfma_f32_32x32x16_bf16 v[56:71], v[116:119], a[72:75], v[56:71]
    ds_read_b64_tr_b16 v[116:117], v13 offset:59392
    ds_read_b64_tr_b16 v[118:119], v13 offset:59904
    s_add_u32 m0, s51, 81920
    s_nop 0
    buffer_load_dwordx4 v11, s[20:23], s64 offen offset:1024 lds
    s_waitcnt lgkmcnt(10)
    v_mfma_f32_32x32x16_bf16 v[40:55], v[120:123], a[76:79], v[40:55]
    ds_read_b64_tr_b16 v[120:121], v13 offset:53248
    ds_read_b64_tr_b16 v[122:123], v13 offset:53760
    s_add_u32 m0, s1, 7392
    s_add_u32 s43, s52, 27648
    buffer_load_dwordx4 v21, s[28:31], s43 offen sc1 lds
    v_mfma_f32_32x32x16_bf16 v[56:71], v[124:127], a[76:79], v[56:71]
    ds_read_b64_tr_b16 v[124:125], v13 offset:61440
    ds_read_b64_tr_b16 v[126:127], v13 offset:61952
    s_add_u32 m0, s51, 81920
    s_add_u32 s64, s54, 718848
    buffer_load_dwordx4 v10, s[20:23], s64 offen offset:2048 lds
    s_waitcnt lgkmcnt(9)
    v_mfma_f32_32x32x16_bf16 v[40:55], v[32:35], a[80:83], v[40:55]
    ds_read_b64_tr_b16 v[32:33], v13 offset:55296
    ds_read_b64_tr_b16 v[34:35], v13 offset:55808
    ds_read_b32 v20, v0 offset:0
    v_mfma_f32_32x32x16_bf16 v[56:71], v[36:39], a[80:83], v[56:71]
    ds_read_b64_tr_b16 v[36:37], v13 offset:63488
    ds_read_b64_tr_b16 v[38:39], v13 offset:64000
    s_add_u32 m0, s51, 81920
    s_nop 0
    buffer_load_dwordx4 v11, s[20:23], s64 offen offset:3072 lds
    s_waitcnt lgkmcnt(9)
    v_mfma_f32_32x32x16_bf16 v[40:55], v[112:115], a[84:87], v[40:55]
    s_waitcnt lgkmcnt(2)
    s_setprio 3
    v_cmp_gt_u32 vcc, s56, v20
    s_setprio 0
    s_cbranch_vccnz L_chk53
L_chk53_x:
    s_add_u32 s56, s56, 1
    ds_read_b64_tr_b16 v[112:113], v12 offset:32768
    ds_read_b64_tr_b16 v[114:115], v12 offset:33280
    s_waitcnt vmcnt(12)
    ds_add_u32 v18, v19 offset:512
    ds_read_b32 v25, v0 offset:1024
    v_mfma_f32_32x32x16_bf16 v[56:71], v[116:119], a[84:87], v[56:71]
    ds_read_b64_tr_b16 v[116:117], v12 offset:40960
    ds_read_b64_tr_b16 v[118:119], v12 offset:41472
    s_add_u32 m0, s51, 98304
    s_add_u32 s64, s54, 917504
    buffer_load_dwordx4 v10, s[20:23], s64 offen lds
    v_mfma_f32_32x32x16_bf16 v[40:55], v[120:123], a[88:91], v[40:55]
    ds_read_b64_tr_b16 v[120:121], v12 offset:34816
    ds_read_b64_tr_b16 v[122:123], v12 offset:35328
    s_waitcnt vmcnt(11)
    ds_add_u32 v18, v19
    s_waitcnt lgkmcnt(5)
    s_setprio 3
    v_cmp_gt_u32 vcc, 25, v25
    s_setprio 0
    s_cbranch_vccnz L_chk54
L_chk54_x:
    v_mfma_f32_32x32x16_bf16 v[56:71], v[124:127], a[88:91], v[56:71]
    ds_read_b64_tr_b16 v[124:125], v12 offset:43008
    ds_read_b64_tr_b16 v[126:127], v12 offset:43520
    s_add_u32 m0, s51, 98304
    s_nop 0
    buffer_load_dwordx4 v11, s[20:23], s64 offen offset:1024 lds
    v_mfma_f32_32x32x16_bf16 v[40:55], v[32:35], a[92:95], v[40:55]
    ds_read_b64_tr_b16 v[32:33], v12 offset:36864
    ds_read_b64_tr_b16 v[34:35], v12 offset:37376
    s_add_u32 m0, s1, 8448
    s_add_u32 s43, s52, 28672
    buffer_load_dwordx4 v21, s[28:31], s43 offen sc1 lds
    v_mfma_f32_32x32x16_bf16 v[56:71], v[36:39], a[92:95], v[56:71]
    ds_read_b64_tr_b16 v[36:37], v12 offset:45056
    ds_read_b64_tr_b16 v[38:39], v12 offset:45568
    s_add_u32 m0, s51, 98304
    s_add_u32 s64, s54, 1112064
    buffer_load_dwordx4 v10, s[20:23], s64 offen offset:2048 lds
    s_waitcnt lgkmcnt(9)
    v_mfma_f32_32x32x16_bf16 v[40:55], v[112:115], a[96:99], v[40:55]
    ds_read_b64_tr_b16 v[112:113], v12 offset:38912
    ds_read_b64_tr_b16 v[114:115], v12 offset:39424
    ds_read_b32 v20, v0 offset:0
    s_add_u32 s45, s66, 0
    s_mov_b64 exec, 0xfff0fff
    buffer_load_dword v5, v23, s[28:31], s45 offen sc1
    s_mov_b64 exec, -1
    v_mfma_f32_32x32x16_bf16 v[56:71], v[116:119], a[96:99], v[56:71]
    ds_read_b64_tr_b16 v[116:117], v12 offset:47104
    ds_read_b64_tr_b16 v[118:119], v12 offset:47616
    s_add_u32 m0, s51, 98304
    s_nop 0
    buffer_load_dwordx4 v11, s[20:23], s64 offen offset:3072 lds
    s_waitcnt lgkmcnt(9)
    v_mfma_f32_32x32x16_bf16 v[40:55], v[120:123], a[100:103], v[40:55]
    s_waitcnt lgkmcnt(2)
    s_setprio 3
    v_cmp_gt_u32 vcc, s56, v20
    s_setprio 0
    s_cbranch_vccnz L_chk55
L_chk55_x:
    s_add_u32 s56, s56, 1
    ds_read_b64_tr_b16 v[120:121], v12 offset:49152
    ds_read_b64_tr_b16 v[122:123], v12 offset:49664
    ds_add_u32 v18, v19
    s_waitcnt vmcnt(13)
    ds_add_u32 v18, v19 offset:512
    v_mfma_f32_32x32x16_bf16 v[56:71], v[124:127], a[100:103], v[56:71]
    ds_read_b64_tr_b16 v[124:125], v12 offset:57344
    ds_read_b64_tr_b16 v[126:127], v12 offset:57856
    s_add_u32 m0, s51, 114688
    s_add_u32 s64, s54, 65536
    buffer_load_dwordx4 v10, s[20:23], s64 offen lds
    v_mfma_f32_32x32x16_bf16 v[40:55], v[32:35], a[104:107], v[40:55]
    ds_read_b64_tr_b16 v[32:33], v12 offset:51200
    ds_read_b64_tr_b16 v[34:35], v12 offset:51712
    s_waitcnt vmcnt(2)
    s_setprio 3
    v_cmp_ne_u32 vcc, s46, v5
    s_setprio 0
    s_and_b32 vcc_lo, vcc_lo, 0xfff0fff
    s_cbranch_scc1 L_hf0_s
L_hf0_b:
    s_add_u32 s45, s68, 0
    buffer_load_dwordx4 a[0:3], v6, s[28:31], s45 offen sc1
    buffer_load_dwordx4 a[4:7], v26, s[28:31], s45 offen sc1
    v_mfma_f32_32x32x16_bf16 v[56:71], v[36:39], a[104:107], v[56:71]
    ds_read_b64_tr_b16 v[36:37], v12 offset:59392
    ds_read_b64_tr_b16 v[38:39], v12 offset:59904
    s_add_u32 m0, s51, 114688
    s_nop 0
    buffer_load_dwordx4 v11, s[20:23], s64 offen offset:1024 lds
    s_waitcnt lgkmcnt(10)
    v_mfma_f32_32x32x16_bf16 v[40:55], v[112:115], a[108:111], v[40:55]
    ds_read_b64_tr_b16 v[112:113], v12 offset:53248
    ds_read_b64_tr_b16 v[114:115], v12 offset:53760
    s_add_u32 m0, s1, 9504
    s_add_u32 s43, s52, 29696
    buffer_load_dwordx4 v21, s[28:31], s43 offen sc1 lds
    v_mfma_f32_32x32x16_bf16 v[56:71], v[116:119], a[108:111], v[56:71]
    ds_read_b64_tr_b16 v[116:117], v12 offset:61440
    ds_read_b64_tr_b16 v[118:119], v12 offset:61952
    s_add_u32 m0, s51, 114688
    s_add_u32 s64, s54, 260096
    buffer_load_dwordx4 v10, s[20:23], s64 offen offset:2048 lds
    s_waitcnt lgkmcnt(8)
    v_mfma_f32_32x32x16_bf16 v[40:55], v[120:123], v[96:99], v[40:55]
    ds_read_b64_tr_b16 v[120:121], v12 offset:55296
    ds_read_b64_tr_b16 v[122:123], v12 offset:55808
    ds_read_b32 v20, v0 offset:0
    s_add_u32 s45, s68, 12288
    buffer_load_dwordx4 a[8:11], v6, s[28:31], s45 offen sc1
    buffer_load_dwordx4 a[12:15], v26, s[28:31], s45 offen sc1
    v_mfma_f32_32x32x16_bf16 v[56:71], v[124:127], v[96:99], v[56:71]
    ds_read_b64_tr_b16 v[124:125], v12 offset:63488
    ds_read_b64_tr_b16 v[126:127], v12 offset:64000
    s_add_u32 m0, s51, 114688
    s_nop 0
    buffer_load_dwordx4 v11, s[20:23], s64 offen offset:3072 lds
    s_waitcnt lgkmcnt(9)
    v_mfma_f32_32x32x16_bf16 v[40:55], v[32:35], v[100:103], v[40:55]
    s_waitcnt lgkmcnt(2)
    s_setprio 3
    v_cmp_gt_u32 vcc, s56, v20
    s_setprio 0
    s_cbranch_vccnz L_chk56
L_chk56_x:
    s_add_u32 s56, s56, 1
    ds_read_b64_tr_b16 v[32:33], v15 offset:0
    ds_read_b64_tr_b16 v[34:35], v15 offset:1024
    ds_add_u32 v18, v19
    s_add_u32 m0, s51, 32768
    s_add_u32 s64, s54, 458752
    buffer_load_dwordx4 v10, s[20:23], s64 offen lds
    ds_add_u32 v18, v19 offset:512
    ds_read_b32 v25, v0 offset:1024
    v_mfma_f32_32x32x16_bf16 v[56:71], v[36:39], v[100:103], v[56:71]
    ds_read_b64_tr_b16 v[36:37], v17 offset:0
    ds_read_b64_tr_b16 v[38:39], v17 offset:1024
    s_add_u32 m0, s51, 32768
    s_nop 0
    buffer_load_dwordx4 v11, s[20:23], s64 offen offset:1024 lds
    s_add_u32 s45, s68, 24576
    buffer_load_dwordx4 a[16:19], v6, s[28:31], s45 offen sc1
    buffer_load_dwordx4 a[20:23], v26, s[28:31], s45 offen sc1
    v_mfma_f32_32x32x16_bf16 v[40:55], v[112:115], v[104:107], v[40:55]
    ds_read_b64_tr_b16 v[112:113], v15 offset:2048
    ds_read_b64_tr_b16 v[114:115], v15 offset:3072
    s_add_u32 m0, s51, 32768
    s_add_u32 s64, s54, 587776
    buffer_load_dwordx4 v10, s[20:23], s64 offen offset:2048 lds
    ds_read_b32 v20, v0 offset:0
    s_waitcnt lgkmcnt(5)
    s_setprio 3
    v_cmp_gt_u32 vcc, 26, v25
    s_setprio 0
    s_cbranch_vccnz L_chk57
L_chk57_x:
    s_add_u32 m0, s1, 0
    s_add_u32 s43, s52, 30720
    buffer_load_dwordx4 v21, s[28:31], s43 offen sc1 lds
    v_mfma_f32_32x32x16_bf16 v[56:71], v[116:119], v[104:107], v[56:71]
    ds_read_b64_tr_b16 v[116:117], v17 offset:2048
    ds_read_b64_tr_b16 v[118:119], v17 offset:3072
    s_add_u32 m0, s51, 32768
    s_nop 0
    buffer_load_dwordx4 v11, s[20:23], s64 offen offset:3072 lds
    s_add_u32 s45, s68, 45056
    buffer_load_dwordx4 a[24:27], v6, s[28:31], s45 offen sc1
    buffer_load_dwordx4 a[28:31], v26, s[28:31], s45 offen sc1
    v_mfma_f32_32x32x16_bf16 v[40:55], v[120:123], v[108:111], v[40:55]
    s_waitcnt lgkmcnt(2)
    s_setprio 3
    v_cmp_gt_u32 vcc, s56, v20
    s_setprio 0
    s_cbranch_vccnz L_chk58
L_chk58_x:
    s_add_u32 s56, s56, 1
    ds_read_b64_tr_b16 v[120:121], v15 offset:16384
    ds_read_b64_tr_b16 v[122:123], v15 offset:17408
    s_add_u32 m0, s51, 49152
    s_add_u32 s64, s54, 786432
    buffer_load_dwordx4 v10, s[20:23], s64 offen lds
    ds_add_u32 v18, v19 offset:512
    v_mfma_f32_32x32x16_bf16 v[56:71], v[124:127], v[108:111], v[56:71]
    ds_read_b64_tr_b16 v[124:125], v17 offset:16384
    ds_read_b64_tr_b16 v[126:127], v17 offset:17408
    s_add_u32 m0, s51, 49152
    s_nop 0
    buffer_load_dwordx4 v11, s[20:23], s64 offen offset:1024 lds
    s_add_u32 s45, s68, 57344
    buffer_load_dwordx4 a[32:35], v6, s[28:31], s45 offen sc1
    buffer_load_dwordx4 a[36:39], v26, s[28:31], s45 offen sc1
    s_add_u32 s45, s66, 4096
    s_mov_b64 exec, 0xffffffff
    buffer_load_dword v5, v23, s[28:31], s45 offen sc1
    s_mov_b64 exec, -1
    s_setprio 3
    s_nop 9
    v_pk_mul_f32 v[72:73], v[40:41], v[40:41]
    v_pk_mul_f32 v[74:75], v[42:43], v[42:43]
    v_pk_mul_f32 v[76:77], v[44:45], v[44:45]
    v_pk_mul_f32 v[78:79], v[46:47], v[46:47]
    v_pk_mul_f32 v[80:81], v[48:49], v[48:49]
    v_pk_mul_f32 v[82:83], v[50:51], v[50:51]
    v_pk_mul_f32 v[84:85], v[52:53], v[52:53]
    v_pk_mul_f32 v[86:87], v[54:55], v[54:55]
    v_pk_fma_f32 v[72:73], v[72:73], s[62:63], v[2:3]
    v_pk_fma_f32 v[74:75], v[74:75], s[62:63], v[2:3]
    v_pk_fma_f32 v[76:77], v[76:77], s[62:63], v[2:3]
    v_pk_fma_f32 v[78:79], v[78:79], s[62:63], v[2:3]
    v_pk_fma_f32 v[80:81], v[80:81], s[62:63], v[2:3]
    v_pk_fma_f32 v[82:83], v[82:83], s[62:63], v[2:3]
    v_pk_fma_f32 v[84:85], v[84:85], s[62:63], v[2:3]
    v_pk_fma_f32 v[86:87], v[86:87], s[62:63], v[2:3]
    v_pk_mul_f32 v[88:89], v[56:57], v[40:41]
    v_pk_mul_f32 v[90:91], v[58:59], v[42:43]
    v_pk_mul_f32 v[92:93], v[60:61], v[44:45]
    v_pk_mul_f32 v[94:95], v[62:63], v[46:47]
    v_pk_mul_f32 v[128:129], v[64:65], v[48:49]
    v_pk_mul_f32 v[130:131], v[66:67], v[50:51]
    v_pk_mul_f32 v[132:133], v[68:69], v[52:53]
    v_pk_mul_f32 v[134:135], v[70:71], v[54:55]
    v_pk_mul_f32 v[72:73], v[72:73], v[40:41]
    v_pk_mul_f32 v[74:75], v[74:75], v[42:43]
    v_pk_mul_f32 v[76:77], v[76:77], v[44:45]
    v_pk_mul_f32 v[78:79], v[78:79], v[46:47]
    v_pk_mul_f32 v[80:81], v[80:81], v[48:49]
    v_pk_mul_f32 v[82:83], v[82:83], v[50:51]
    v_pk_mul_f32 v[84:85], v[84:85], v[52:53]
    v_pk_mul_f32 v[86:87], v[86:87], v[54:55]
    s_setprio 0
    s_waitcnt vmcnt(20)
    v_mfma_f32_32x32x16_bf16 v[40:55], v[32:35], a[0:3], 0
    s_setprio 3
    v_exp_f32 v72, v72
    v_exp_f32 v73, v73
    v_exp_f32 v74, v74
    v_exp_f32 v75, v75
    s_setprio 0
    s_setprio 3
    v_exp_f32 v76, v76
    v_exp_f32 v77, v77
    v_exp_f32 v78, v78
    v_exp_f32 v79, v79
    s_setprio 0
    v_mfma_f32_32x32x16_bf16 v[56:71], v[32:35], a[4:7], 0
    s_setprio 3
    v_exp_f32 v80, v80
    v_exp_f32 v81, v81
    v_exp_f32 v82, v82
    v_exp_f32 v83, v83
    s_setprio 0
    s_setprio 3
    v_exp_f32 v84, v84
    v_exp_f32 v85, v85
    v_exp_f32 v86, v86
    v_exp_f32 v87, v87
    s_setprio 0
    ds_read_b64_tr_b16 v[32:33], v15 offset:18432
    ds_read_b64_tr_b16 v[34:35], v15 offset:19456
    s_add_u32 m0, s51, 49152
    s_add_u32 s64, s54, 980992
    buffer_load_dwordx4 v10, s[20:23], s64 offen offset:2048 lds
    s_add_u32 m0, s1, 1056
    s_add_u32 s43, s52, 31744
    buffer_load_dwordx4 v21, s[28:31], s43 offen sc1 lds
    v_mfma_f32_32x32x16_bf16 v[96:111], v[36:39], a[0:3], 0
    s_setprio 3
    v_pk_add_f32 v[72:73], v[72:73], 1.0 op_sel_hi:[1,0]
    v_pk_add_f32 v[74:75], v[74:75], 1.0 op_sel_hi:[1,0]
    v_pk_add_f32 v[76:77], v[76:77], 1.0 op_sel_hi:[1,0]
    v_pk_add_f32 v[78:79], v[78:79], 1.0 op_sel_hi:[1,0]
    v_pk_add_f32 v[80:81], v[80:81], 1.0 op_sel_hi:[1,0]
    v_pk_add_f32 v[82:83], v[82:83], 1.0 op_sel_hi:[1,0]
    v_pk_add_f32 v[84:85], v[84:85], 1.0 op_sel_hi:[1,0]
    v_pk_add_f32 v[86:87], v[86:87], 1.0 op_sel_hi:[1,0]
    s_setprio 0
    s_setprio 3
    v_rcp_f32 v72, v72
    v_rcp_f32 v73, v73
    v_rcp_f32 v74, v74
    v_rcp_f32 v75, v75
    s_setprio 0
    v_mfma_f32_32x32x16_bf16 a[96:111], v[36:39], a[4:7], 0
    s_setprio 3
    v_rcp_f32 v76, v76
    v_rcp_f32 v77, v77
    v_rcp_f32 v78, v78
    v_rcp_f32 v79, v79
    s_setprio 0
    s_setprio 3
    v_rcp_f32 v80, v80
    v_rcp_f32 v81, v81
    v_rcp_f32 v82, v82
    v_rcp_f32 v83, v83
    s_setprio 0
    ds_read_b64_tr_b16 v[36:37], v17 offset:18432
    ds_read_b64_tr_b16 v[38:39], v17 offset:19456
    s_add_u32 m0, s51, 49152
    s_nop 0
    buffer_load_dwordx4 v11, s[20:23], s64 offen offset:3072 lds
    s_add_u32 s45, s68, 69632
    buffer_load_dwordx4 a[40:43], v6, s[28:31], s45 offen sc1
    buffer_load_dwordx4 a[44:47], v26, s[28:31], s45 offen sc1
    s_waitcnt vmcnt(20)
    v_mfma_f32_32x32x16_bf16 v[40:55], v[112:115], a[8:11], v[40:55]
    s_setprio 3
    v_rcp_f32 v84, v84
    v_rcp_f32 v85, v85
    v_rcp_f32 v86, v86
    v_rcp_f32 v87, v87
    s_setprio 0
    s_setprio 3
    v_pk_mul_f32 v[88:89], v[88:89], v[72:73]
    v_pk_mul_f32 v[90:91], v[90:91], v[74:75]
    v_pk_mul_f32 v[92:93], v[92:93], v[76:77]
    v_pk_mul_f32 v[94:95], v[94:95], v[78:79]
    v_pk_mul_f32 v[128:129], v[128:129], v[80:81]
    v_pk_mul_f32 v[130:131], v[130:131], v[82:83]
    v_pk_mul_f32 v[132:133], v[132:133], v[84:85]
    v_pk_mul_f32 v[134:135], v[134:135], v[86:87]
    s_setprio 0
    v_mfma_f32_32x32x16_bf16 v[56:71], v[112:115], a[12:15], v[56:71]
    s_setprio 3
    v_cvt_pk_bf16_f32 v72, v88, v89
    v_cvt_pk_bf16_f32 v73, v90, v91
    v_cvt_pk_bf16_f32 v74, v92, v93
    v_cvt_pk_bf16_f32 v75, v94, v95
    v_cvt_pk_bf16_f32 v76, v128, v129
    v_cvt_pk_bf16_f32 v77, v130, v131
    v_cvt_pk_bf16_f32 v78, v132, v133
    v_cvt_pk_bf16_f32 v79, v134, v135
    s_setprio 0
    s_add_u32 s43, s42, s50
    s_cmp_eq_u32 s43, 8
    s_cbranch_scc1 L_hskip59
    s_add_u32 s43, s58, 8192
    buffer_store_dwordx4 v[72:75], v21, s[28:31], s43 offen sc1
    buffer_store_dwordx4 v[76:79], v21, s[28:31], s43 offen offset:1024 sc1
L_hskip59:
    ds_read_b64_tr_b16 v[112:113], v15 offset:32768
    ds_read_b64_tr_b16 v[114:115], v15 offset:33792
    s_add_u32 m0, s51, 65536
    s_add_u32 s64, s54, 1179648
    buffer_load_dwordx4 v10, s[20:23], s64 offen lds
    ds_add_u32 v18, v19 offset:512
    s_waitcnt lgkmcnt(12)
    v_mfma_f32_32x32x16_bf16 v[96:111], v[116:119], a[8:11], v[96:111]
    v_mfma_f32_32x32x16_bf16 a[96:111], v[116:119], a[12:15], a[96:111]
    ds_read_b64_tr_b16 v[116:117], v17 offset:32768
    ds_read_b64_tr_b16 v[118:119], v17 offset:33792
    s_add_u32 m0, s51, 65536
    s_nop 0
    buffer_load_dwordx4 v11, s[20:23], s64 offen offset:1024 lds
    s_waitcnt vmcnt(2)
    s_add_u32 s43, s61, 8192
    s_mov_b64 exec, 1
    buffer_store_dword v22, v4, s[28:31], s43 offen sc1
    s_mov_b64 exec, -1
    s_setprio 3
    v_cmp_ne_u32 vcc, s46, v5
    s_setprio 0
    s_and_b32 vcc_lo, vcc_lo, 0xffffffff
    s_cbranch_scc1 L_hf1_s
L_hf1_b:
    s_add_u32 s45, s68, 4096
    buffer_load_dwordx4 a[48:51], v6, s[28:31], s45 offen sc1
    buffer_load_dwordx4 a[52:55], v26, s[28:31], s45 offen sc1
    s_waitcnt lgkmcnt(12)
    v_mfma_f32_32x32x16_bf16 v[40:55], v[120:123], a[16:19], v[40:55]
    v_mfma_f32_32x32x16_bf16 v[56:71], v[120:123], a[20:23], v[56:71]
    ds_read_b64_tr_b16 v[120:121], v15 offset:34816
    ds_read_b64_tr_b16 v[122:123], v15 offset:35840
    s_add_u32 m0, s51, 65536
    s_add_u32 s64, s54, 1308672
    buffer_load_dwordx4 v10, s[20:23], s64 offen offset:2048 lds
    s_waitcnt lgkmcnt(11)
    v_mfma_f32_32x32x16_bf16 v[96:111], v[124:127], a[16:19], v[96:111]
    v_mfma_f32_32x32x16_bf16 a[96:111], v[124:127], a[20:23], a[96:111]
    ds_read_b64_tr_b16 v[124:125], v17 offset:34816
    ds_read_b64_tr_b16 v[126:127], v17 offset:35840
    s_add_u32 m0, s51, 65536
    s_nop 0
    buffer_load_dwordx4 v11, s[20:23], s64 offen offset:3072 lds
    s_add_u32 s45, s68, 16384
    buffer_load_dwordx4 a[56:59], v6, s[28:31], s45 offen sc1
    buffer_load_dwordx4 a[60:63], v26, s[28:31], s45 offen sc1
    s_waitcnt lgkmcnt(11)
    v_mfma_f32_32x32x16_bf16 v[40:55], v[32:35], a[24:27], v[40:55]
    v_mfma_f32_32x32x16_bf16 v[56:71], v[32:35], a[28:31], v[56:71]
    ds_read_b64_tr_b16 v[32:33], v15 offset:49152
    ds_read_b64_tr_b16 v[34:35], v15 offset:50176
    s_add_u32 m0, s51, 81920
    s_add_u32 s64, s54, 131072
    buffer_load_dwordx4 v10, s[20:23], s64 offen lds
    ds_add_u32 v18, v19 offset:512
    s_waitcnt lgkmcnt(12)
    v_mfma_f32_32x32x16_bf16 v[96:111], v[36:39], a[24:27], v[96:111]
    v_mfma_f32_32x32x16_bf16 a[96:111], v[36:39], a[28:31], a[96:111]
    ds_read_b64_tr_b16 v[36:37], v17 offset:49152
    ds_read_b64_tr_b16 v[38:39], v17 offset:50176
    s_add_u32 m0, s51, 81920
    s_nop 0
    buffer_load_dwordx4 v11, s[20:23], s64 offen offset:1024 lds
    s_add_u32 s45, s68, 28672
    buffer_load_dwordx4 a[64:67], v6, s[28:31], s45 offen sc1
    buffer_load_dwordx4 a[68:71], v26, s[28:31], s45 offen sc1
    s_waitcnt lgkmcnt(12)
    v_mfma_f32_32x32x16_bf16 v[40:55], v[112:115], a[32:35], v[40:55]
    v_mfma_f32_32x32x16_bf16 v[56:71], v[112:115], a[36:39], v[56:71]
    ds_read_b64_tr_b16 v[112:113], v15 offset:51200
    ds_read_b64_tr_b16 v[114:115], v15 offset:52224
    s_add_u32 m0, s51, 81920
    s_add_u32 s64, s54, 325632
    buffer_load_dwordx4 v10, s[20:23], s64 offen offset:2048 lds
    s_waitcnt lgkmcnt(11)
    v_mfma_f32_32x32x16_bf16 v[96:111], v[116:119], a[32:35], v[96:111]
    v_mfma_f32_32x32x16_bf16 a[96:111], v[116:119], a[36:39], a[96:111]
    ds_read_b64_tr_b16 v[116:117], v17 offset:51200
    ds_read_b64_tr_b16 v[118:119], v17 offset:52224
    s_add_u32 m0, s51, 81920
    s_nop 0
    buffer_load_dwordx4 v11, s[20:23], s64 offen offset:3072 lds
    s_add_u32 s45, s68, 36864
    buffer_load_dwordx4 a[72:75], v6, s[28:31], s45 offen sc1
    buffer_load_dwordx4 a[76:79], v26, s[28:31], s45 offen sc1
    s_waitcnt lgkmcnt(11)
    v_mfma_f32_32x32x16_bf16 v[40:55], v[120:123], a[40:43], v[40:55]
    v_mfma_f32_32x32x16_bf16 v[56:71], v[120:123], a[44:47], v[56:71]
    ds_read_b64_tr_b16 v[120:121], v14 offset:32768
    ds_read_b64_tr_b16 v[122:123], v14 offset:33792
    s_add_u32 m0, s51, 98304
    s_add_u32 s64, s54, 524288
    buffer_load_dwordx4 v10, s[20:23], s64 offen lds
    ds_add_u32 v18, v19 offset:512
    buffer_load_dwordx2 v[136:137], v28, s[8:11], s67 offen offset:0
    buffer_load_dwordx2 v[138:139], v28, s[8:11], s67 offen offset:16
    buffer_load_dwordx2 v[140:141], v28, s[8:11], s67 offen offset:32
    buffer_load_dwordx2 v[142:143], v28, s[8:11], s67 offen offset:48
    s_waitcnt lgkmcnt(12)
    v_mfma_f32_32x32x16_bf16 v[96:111], v[124:127], a[40:43], v[96:111]
    v_mfma_f32_32x32x16_bf16 a[96:111], v[124:127], a[44:47], a[96:111]
    ds_read_b64_tr_b16 v[124:125], v16 offset:32768
    ds_read_b64_tr_b16 v[126:127], v16 offset:33792
    s_add_u32 m0, s51, 98304
    s_nop 0
    buffer_load_dwordx4 v11, s[20:23], s64 offen offset:1024 lds
    s_add_u32 s45, s68, 49152
    buffer_load_dwordx4 a[80:83], v6, s[28:31], s45 offen sc1
    buffer_load_dwordx4 a[84:87], v26, s[28:31], s45 offen sc1
    s_waitcnt lgkmcnt(12)
    s_waitcnt vmcnt(20)
    v_mfma_f32_32x32x16_bf16 v[40:55], v[32:35], a[48:51], v[40:55]
    v_mfma_f32_32x32x16_bf16 v[56:71], v[32:35], a[52:55], v[56:71]
    ds_read_b64_tr_b16 v[32:33], v14 offset:34816
    ds_read_b64_tr_b16 v[34:35], v14 offset:35840
    s_add_u32 m0, s51, 98304
    s_add_u32 s64, s54, 653312
    buffer_load_dwordx4 v10, s[20:23], s64 offen offset:2048 lds
    s_waitcnt lgkmcnt(11)
    v_mfma_f32_32x32x16_bf16 v[96:111], v[36:39], a[48:51], v[96:111]
    v_mfma_f32_32x32x16_bf16 a[96:111], v[36:39], a[52:55], a[96:111]
    ds_read_b64_tr_b16 v[36:37], v16 offset:34816
    ds_read_b64_tr_b16 v[38:39], v16 offset:35840
    s_add_u32 m0, s51, 98304
    s_nop 0
    buffer_load_dwordx4 v11, s[20:23], s64 offen offset:3072 lds
    s_add_u32 s45, s68, 61440
    buffer_load_dwordx4 a[88:91], v6, s[28:31], s45 offen sc1
    buffer_load_dwordx4 a[92:95], v26, s[28:31], s45 offen sc1
    s_waitcnt lgkmcnt(11)
    s_waitcnt vmcnt(20)
    v_mfma_f32_32x32x16_bf16 v[40:55], v[112:115], a[56:59], v[40:55]
    v_mfma_f32_32x32x16_bf16 v[56:71], v[112:115], a[60:63], v[56:71]
    ds_read_b64_tr_b16 v[112:113], v14 offset:49152
    ds_read_b64_tr_b16 v[114:115], v14 offset:50176
    s_add_u32 m0, s51, 114688
    s_add_u32 s64, s54, 851968
    buffer_load_dwordx4 v10, s[20:23], s64 offen lds
    s_waitcnt lgkmcnt(11)
    v_mfma_f32_32x32x16_bf16 v[96:111], v[116:119], a[56:59], v[96:111]
    v_mfma_f32_32x32x16_bf16 a[96:111], v[116:119], a[60:63], a[96:111]
    ds_read_b64_tr_b16 v[116:117], v16 offset:49152
    ds_read_b64_tr_b16 v[118:119], v16 offset:50176
    s_add_u32 m0, s51, 114688
    s_nop 0
    buffer_load_dwordx4 v11, s[20:23], s64 offen offset:1024 lds
    s_add_u32 s45, s68, 73728
    buffer_load_dwordx4 a[0:3], v6, s[28:31], s45 offen sc1
    buffer_load_dwordx4 a[4:7], v26, s[28:31], s45 offen sc1
    s_add_u32 s45, s66, 8192
    s_mov_b64 exec, 0xffffffff
    buffer_load_dword v5, v23, s[28:31], s45 offen sc1
    s_mov_b64 exec, -1
    s_waitcnt lgkmcnt(11)
    s_waitcnt vmcnt(21)
    v_mfma_f32_32x32x16_bf16 v[40:55], v[120:123], a[64:67], v[40:55]
    v_mfma_f32_32x32x16_bf16 v[56:71], v[120:123], a[68:71], v[56:71]
    ds_read_b64_tr_b16 v[120:121], v14 offset:51200
    ds_read_b64_tr_b16 v[122:123], v14 offset:52224
    s_add_u32 m0, s51, 114688
    s_add_u32 s64, s54, 1046528
    buffer_load_dwordx4 v10, s[20:23], s64 offen offset:2048 lds
    s_waitcnt lgkmcnt(10)
    v_mfma_f32_32x32x16_bf16 v[96:111], v[124:127], a[64:67], v[96:111]
    v_mfma_f32_32x32x16_bf16 a[96:111], v[124:127], a[68:71], a[96:111]
    ds_read_b64_tr_b16 v[124:125], v16 offset:51200
    ds_read_b64_tr_b16 v[126:127], v16 offset:52224
    s_add_u32 m0, s51, 114688
    s_nop 0
    buffer_load_dwordx4 v11, s[20:23], s64 offen offset:3072 lds
    s_add_u32 s45, s68, 81920
    buffer_load_dwordx4 a[8:11], v6, s[28:31], s45 offen sc1
    buffer_load_dwordx4 a[12:15], v26, s[28:31], s45 offen sc1
    s_waitcnt lgkmcnt(10)
    s_waitcnt vmcnt(21)
    v_mfma_f32_32x32x16_bf16 v[40:55], v[32:35], a[72:75], v[40:55]
    v_mfma_f32_32x32x16_bf16 v[56:71], v[32:35], a[76:79], v[56:71]
    ds_read_b64_tr_b16 v[32:33], v15 offset:0
    ds_read_b64_tr_b16 v[34:35], v15 offset:1024
    s_add_u32 m0, s51, 32768
    s_add_u32 s64, s54, 1245184
    buffer_load_dwordx4 v10, s[20:23], s64 offen lds
    s_waitcnt lgkmcnt(10)
    v_mfma_f32_32x32x16_bf16 v[96:111], v[36:39], a[72:75], v[96:111]
    v_mfma_f32_32x32x16_bf16 a[96:111], v[36:39], a[76:79], a[96:111]
    ds_read_b64_tr_b16 v[36:37], v17 offset:0
    ds_read_b64_tr_b16 v[38:39], v17 offset:1024
    s_add_u32 m0, s51, 32768
    s_nop 0
    buffer_load_dwordx4 v11, s[20:23], s64 offen offset:1024 lds
    s_waitcnt vmcnt(6)
    s_setprio 3
    v_cmp_ne_u32 vcc, s46, v5
    s_setprio 0
    s_and_b32 vcc_lo, vcc_lo, 0xffffffff
    s_cbranch_scc1 L_hf2_s
L_hf2_b:
    s_add_u32 s45, s68, 8192
    buffer_load_dwordx4 a[16:19], v6, s[28:31], s45 offen sc1
    buffer_load_dwordx4 a[20:23], v26, s[28:31], s45 offen sc1
    s_waitcnt lgkmcnt(10)
    v_mfma_f32_32x32x16_bf16 v[40:55], v[112:115], a[80:83], v[40:55]
    v_mfma_f32_32x32x16_bf16 v[56:71], v[112:115], a[84:87], v[56:71]
    ds_read_b64_tr_b16 v[112:113], v15 offset:2048
    ds_read_b64_tr_b16 v[114:115], v15 offset:3072
    s_add_u32 m0, s51, 32768
    s_add_u32 s64, s54, 1374208
    buffer_load_dwordx4 v10, s[20:23], s64 offen offset:2048 lds
    s_waitcnt lgkmcnt(10)
    v_mfma_f32_32x32x16_bf16 v[96:111], v[116:119], a[80:83], v[96:111]
    v_mfma_f32_32x32x16_bf16 a[96:111], v[116:119], a[84:87], a[96:111]
    ds_read_b64_tr_b16 v[116:117], v17 offset:2048
    ds_read_b64_tr_b16 v[118:119], v17 offset:3072
    s_add_u32 m0, s51, 32768
    s_nop 0
    buffer_load_dwordx4 v11, s[20:23], s64 offen offset:3072 lds
    s_add_u32 s45, s68, 20480
    buffer_load_dwordx4 a[24:27], v6, s[28:31], s45 offen sc1
    buffer_load_dwordx4 a[28:31], v26, s[28:31], s45 offen sc1
    s_waitcnt lgkmcnt(10)
    v_mfma_f32_32x32x16_bf16 v[40:55], v[120:123], a[88:91], v[40:55]
    v_mfma_f32_32x32x16_bf16 v[56:71], v[120:123], a[92:95], v[56:71]
    s_waitcnt lgkmcnt(0)
    s_add_u32 m0, s51, 49152
    s_add_u32 s64, s55, 0
    buffer_load_dwordx4 v10, s[24:27], s64 offen lds
    s_add_u32 m0, s51, 49152
    s_nop 0
    buffer_load_dwordx4 v11, s[24:27], s64 offen offset:1024 lds
    s_add_u32 m0, s51, 49152
    s_add_u32 s64, s55, 14336
    buffer_load_dwordx4 v10, s[24:27], s64 offen offset:2048 lds
    s_add_u32 m0, s51, 49152
    s_nop 0
    buffer_load_dwordx4 v11, s[24:27], s64 offen offset:3072 lds
    s_add_u32 m0, s51, 65536
    s_add_u32 s64, s55, 32768
    buffer_load_dwordx4 v10, s[24:27], s64 offen lds
    s_add_u32 m0, s51, 65536
    s_nop 0
    buffer_load_dwordx4 v11, s[24:27], s64 offen offset:1024 lds
    s_add_u32 m0, s51, 65536
    s_add_u32 s64, s55, 47104
    buffer_load_dwordx4 v10, s[24:27], s64 offen offset:2048 lds
    s_add_u32 m0, s51, 65536
    s_nop 0
    buffer_load_dwordx4 v11, s[24:27], s64 offen offset:3072 lds
    s_add_u32 s45, s68, 32768
    buffer_load_dwordx4 a[32:35], v6, s[28:31], s45 offen sc1
    buffer_load_dwordx4 a[36:39], v26, s[28:31], s45 offen sc1
    s_add_u32 s45, s68, 40960
    buffer_load_dwordx4 a[40:43], v6, s[28:31], s45 offen sc1
    buffer_load_dwordx4 a[44:47], v26, s[28:31], s45 offen sc1
    s_add_u32 s45, s68, 53248
    buffer_load_dwordx4 a[48:51], v6, s[28:31], s45 offen sc1
    buffer_load_dwordx4 a[52:55], v26, s[28:31], s45 offen sc1
    s_add_u32 s45, s68, 65536
    buffer_load_dwordx4 a[56:59], v6, s[28:31], s45 offen sc1
    buffer_load_dwordx4 a[60:63], v26, s[28:31], s45 offen sc1
    ds_read_b32 v20, v0 offset:1024
    s_waitcnt lgkmcnt(0)
    s_setprio 3
    v_cmp_gt_u32 vcc, 30, v20
    s_setprio 0
    s_cbranch_vccnz L_chk60
L_chk60_x:
    ds_read_b64_tr_b16 v[120:121], v15 offset:16384
    ds_read_b64_tr_b16 v[122:123], v15 offset:17408
    v_mfma_f32_32x32x16_bf16 v[96:111], v[124:127], a[88:91], v[96:111]
    v_mfma_f32_32x32x16_bf16 a[96:111], v[124:127], a[92:95], a[96:111]
    ds_read_b64_tr_b16 v[124:125], v17 offset:16384
    ds_read_b64_tr_b16 v[126:127], v17 offset:17408
    v_mfma_f32_32x32x16_bf16 v[40:55], v[32:35], a[0:3], v[40:55]
    v_mfma_f32_32x32x16_bf16 v[56:71], v[32:35], a[4:7], v[56:71]
    ds_read_b64_tr_b16 v[32:33], v15 offset:18432
    ds_read_b64_tr_b16 v[34:35], v15 offset:19456
    v_mfma_f32_32x32x16_bf16 v[96:111], v[36:39], a[0:3], v[96:111]
    v_mfma_f32_32x32x16_bf16 a[96:111], v[36:39], a[4:7], a[96:111]
    ds_read_b64_tr_b16 v[36:37], v17 offset:18432
    ds_read_b64_tr_b16 v[38:39], v17 offset:19456
    s_waitcnt vmcnt(24)
    v_mfma_f32_32x32x16_bf16 v[40:55], v[112:115], a[8:11], v[40:55]
    v_mfma_f32_32x32x16_bf16 v[56:71], v[112:115], a[12:15], v[56:71]
    ds_read_b64_tr_b16 v[112:113], v15 offset:32768
    ds_read_b64_tr_b16 v[114:115], v15 offset:33792
    v_mfma_f32_32x32x16_bf16 v[96:111], v[116:119], a[8:11], v[96:111]
    v_mfma_f32_32x32x16_bf16 a[96:111], v[116:119], a[12:15], a[96:111]
    ds_read_b64_tr_b16 v[116:117], v17 offset:32768
    ds_read_b64_tr_b16 v[118:119], v17 offset:33792
    s_waitcnt lgkmcnt(10)
    s_waitcnt vmcnt(20)
    v_mfma_f32_32x32x16_bf16 v[40:55], v[120:123], a[16:19], v[40:55]
    v_mfma_f32_32x32x16_bf16 v[56:71], v[120:123], a[20:23], v[56:71]
    ds_read_b64_tr_b16 v[120:121], v15 offset:34816
    ds_read_b64_tr_b16 v[122:123], v15 offset:35840
    s_waitcnt lgkmcnt(10)
    v_mfma_f32_32x32x16_bf16 v[96:111], v[124:127], a[16:19], v[96:111]
    v_mfma_f32_32x32x16_bf16 a[96:111], v[124:127], a[20:23], a[96:111]
    ds_read_b64_tr_b16 v[124:125], v17 offset:34816
    ds_read_b64_tr_b16 v[126:127], v17 offset:35840
    s_waitcnt lgkmcnt(10)
    s_waitcnt vmcnt(16)
    v_mfma_f32_32x32x16_bf16 v[40:55], v[32:35], a[24:27], v[40:55]
    v_mfma_f32_32x32x16_bf16 v[56:71], v[32:35], a[28:31], v[56:71]
    ds_read_b64_tr_b16 v[32:33], v15 offset:49152
    ds_read_b64_tr_b16 v[34:35], v15 offset:50176
    s_add_u32 m0, s51, 81920
    s_add_u32 s64, s55, 65536
    buffer_load_dwordx4 v10, s[24:27], s64 offen lds
    s_waitcnt lgkmcnt(10)
    v_mfma_f32_32x32x16_bf16 v[96:111], v[36:39], a[24:27], v[96:111]
    v_mfma_f32_32x32x16_bf16 a[96:111], v[36:39], a[28:31], a[96:111]
    ds_read_b64_tr_b16 v[36:37], v17 offset:49152
    ds_read_b64_tr_b16 v[38:39], v17 offset:50176
    s_add_u32 m0, s51, 81920
    s_nop 0
    buffer_load_dwordx4 v11, s[24:27], s64 offen offset:1024 lds
    s_add_u32 s45, s68, 77824
    buffer_load_dwordx4 a[64:67], v6, s[28:31], s45 offen sc1
    buffer_load_dwordx4 a[68:71], v26, s[28:31], s45 offen sc1
    s_waitcnt lgkmcnt(10)
    s_waitcnt vmcnt(10)
    v_mfma_f32_32x32x16_bf16 v[40:55], v[112:115], a[32:35], v[40:55]
    v_mfma_f32_32x32x16_bf16 v[56:71], v[112:115], a[36:39], v[56:71]
    ds_read_b64_tr_b16 v[112:113], v15 offset:51200
    ds_read_b64_tr_b16 v[114:115], v15 offset:52224
    s_add_u32 m0, s51, 81920
    s_add_u32 s64, s55, 79872
    buffer_load_dwordx4 v10, s[24:27], s64 offen offset:2048 lds
    s_waitcnt lgkmcnt(10)
    v_mfma_f32_32x32x16_bf16 v[96:111], v[116:119], a[32:35], v[96:111]
    v_mfma_f32_32x32x16_bf16 a[96:111], v[116:119], a[36:39], a[96:111]
    ds_read_b64_tr_b16 v[116:117], v17 offset:51200
    ds_read_b64_tr_b16 v[118:119], v17 offset:52224
    s_add_u32 m0, s51, 81920
    s_nop 0
    buffer_load_dwordx4 v11, s[24:27], s64 offen offset:3072 lds
    s_and_b32 s45, s48, 2
    s_lshl_b32 s45, s45, 10
    s_sub_u32 s45, s68, s45
    s_add_u32 s45, s45, 86016
    buffer_load_dwordx4 a[72:75], v6, s[28:31], s45 offen sc1
    buffer_load_dwordx4 a[76:79], v26, s[28:31], s45 offen sc1
    s_waitcnt lgkmcnt(10)
    s_waitcnt vmcnt(12)
    v_mfma_f32_32x32x16_bf16 v[40:55], v[120:123], a[40:43], v[40:55]
    v_mfma_f32_32x32x16_bf16 v[56:71], v[120:123], a[44:47], v[56:71]
    ds_read_b64_tr_b16 v[120:121], v14 offset:32768
    ds_read_b64_tr_b16 v[122:123], v14 offset:33792
    s_add_u32 m0, s51, 98304
    s_add_u32 s64, s55, 98304
    buffer_load_dwordx4 v10, s[24:27], s64 offen lds
    s_waitcnt lgkmcnt(10)
    v_mfma_f32_32x32x16_bf16 v[96:111], v[124:127], a[40:43], v[96:111]
    v_mfma_f32_32x32x16_bf16 a[96:111], v[124:127], a[44:47], a[96:111]
    ds_read_b64_tr_b16 v[124:125], v16 offset:32768
    ds_read_b64_tr_b16 v[126:127], v16 offset:33792
    s_add_u32 m0, s51, 98304
    s_nop 0
    buffer_load_dwordx4 v11, s[24:27], s64 offen offset:1024 lds
    s_waitcnt lgkmcnt(10)
    s_waitcnt vmcnt(12)
    v_mfma_f32_32x32x16_bf16 v[40:55], v[32:35], a[48:51], v[40:55]
    v_mfma_f32_32x32x16_bf16 v[56:71], v[32:35], a[52:55], v[56:71]
    ds_read_b64_tr_b16 v[32:33], v14 offset:34816
    ds_read_b64_tr_b16 v[34:35], v14 offset:35840
    s_add_u32 m0, s51, 98304
    s_add_u32 s64, s55, 112640
    buffer_load_dwordx4 v10, s[24:27], s64 offen offset:2048 lds
    s_waitcnt lgkmcnt(10)
    v_mfma_f32_32x32x16_bf16 v[96:111], v[36:39], a[48:51], v[96:111]
    v_mfma_f32_32x32x16_bf16 a[96:111], v[36:39], a[52:55], a[96:111]
    ds_read_b64_tr_b16 v[36:37], v16 offset:34816
    ds_read_b64_tr_b16 v[38:39], v16 offset:35840
    s_add_u32 m0, s51, 98304
    s_nop 0
    buffer_load_dwordx4 v11, s[24:27], s64 offen offset:3072 lds
    s_waitcnt lgkmcnt(10)
    s_waitcnt vmcnt(12)
    v_mfma_f32_32x32x16_bf16 v[40:55], v[112:115], a[56:59], v[40:55]
    v_mfma_f32_32x32x16_bf16 v[56:71], v[112:115], a[60:63], v[56:71]
    s_waitcnt lgkmcnt(8)
    v_mfma_f32_32x32x16_bf16 v[96:111], v[116:119], a[56:59], v[96:111]
    v_mfma_f32_32x32x16_bf16 a[96:111], v[116:119], a[60:63], a[96:111]
    s_waitcnt lgkmcnt(6)
    s_waitcnt vmcnt(8)
    v_mfma_f32_32x32x16_bf16 v[40:55], v[120:123], a[64:67], v[40:55]
    v_mfma_f32_32x32x16_bf16 v[56:71], v[120:123], a[68:71], v[56:71]
    s_waitcnt lgkmcnt(4)
    v_mfma_f32_32x32x16_bf16 v[96:111], v[124:127], a[64:67], v[96:111]
    v_mfma_f32_32x32x16_bf16 a[96:111], v[124:127], a[68:71], a[96:111]
    s_waitcnt lgkmcnt(2)
    s_waitcnt vmcnt(4)
    v_mfma_f32_32x32x16_bf16 v[40:55], v[32:35], a[72:75], v[40:55]
    v_mfma_f32_32x32x16_bf16 v[56:71], v[32:35], a[76:79], v[56:71]
    s_waitcnt lgkmcnt(0)
    v_mfma_f32_32x32x16_bf16 v[96:111], v[36:39], a[72:75], v[96:111]
    v_mfma_f32_32x32x16_bf16 a[96:111], v[36:39], a[76:79], a[96:111]
    s_waitcnt vmcnt(0)
    ds_read_b64_tr_b16 a[0:1], v14 offset:49152
    ds_read_b64_tr_b16 a[2:3], v14 offset:50176
    ds_read_b64_tr_b16 a[4:5], v16 offset:49152
    ds_read_b64_tr_b16 a[6:7], v16 offset:50176
    ds_read_b64_tr_b16 a[8:9], v14 offset:51200
    ds_read_b64_tr_b16 a[10:11], v14 offset:52224
    ds_read_b64_tr_b16 a[12:13], v16 offset:51200
    ds_read_b64_tr_b16 a[14:15], v16 offset:52224
    ds_read_b64_tr_b16 a[16:17], v15 offset:0
    ds_read_b64_tr_b16 a[18:19], v15 offset:1024
    ds_read_b64_tr_b16 a[20:21], v17 offset:0
    ds_read_b64_tr_b16 a[22:23], v17 offset:1024
    ds_read_b64_tr_b16 a[24:25], v15 offset:2048
    ds_read_b64_tr_b16 a[26:27], v15 offset:3072
    ds_read_b64_tr_b16 a[28:29], v17 offset:2048
    s_waitcnt lgkmcnt(12)
    ds_read_b64_tr_b16 a[30:31], v17 offset:3072
    ds_read_b64_tr_b16 a[32:33], v15 offset:16384
    ds_read_b64_tr_b16 a[34:35], v15 offset:17408
    s_waitcnt lgkmcnt(12)
    ds_read_b64_tr_b16 a[36:37], v17 offset:16384
    ds_read_b64_tr_b16 a[38:39], v17 offset:17408
    ds_read_b64_tr_b16 a[40:41], v15 offset:18432
    s_waitcnt lgkmcnt(12)
    ds_read_b64_tr_b16 a[42:43], v15 offset:19456
    ds_read_b64_tr_b16 a[44:45], v17 offset:18432
    ds_read_b64_tr_b16 a[46:47], v17 offset:19456
    s_waitcnt lgkmcnt(12)
    ds_read_b64_tr_b16 a[48:49], v15 offset:32768
    ds_read_b64_tr_b16 a[50:51], v15 offset:33792
    ds_read_b64_tr_b16 a[52:53], v17 offset:32768
    s_waitcnt lgkmcnt(12)
    ds_read_b64_tr_b16 a[54:55], v17 offset:33792
    ds_read_b64_tr_b16 a[56:57], v15 offset:34816
    ds_read_b64_tr_b16 a[58:59], v15 offset:35840
    s_waitcnt lgkmcnt(12)
    ds_read_b64_tr_b16 a[60:61], v17 offset:34816
    ds_read_b64_tr_b16 a[62:63], v17 offset:35840
    s_setprio 3
    s_lshl_b32 s7, s41, 16
    s_lshl_b32 s43, s48, 13
    s_add_u32 s7, s7, s43
    s_add_u32 s7, s7, 6291456
    s_add_u32 s6, s7, 4096
    s_mov_b32 s4, 0
    s_mov_b32 s5, 0
    s_mov_b32 s62, 0xbfb8aa3b
    s_mov_b32 s63, 0xbfb8aa3b
    v_xor_b32 v24, 4096, v29
    v_xor_b32 v25, 8192, v29
    v_xor_b32 v31, 12288, v29
    v_and_b32 v23, 7, v1
    v_lshlrev_b32 v23, 10, v23
    v_bfe_u32 v22, v1, 3, 1
    v_lshl_add_u32 v23, v22, 15, v23
    v_add_u32 v29, 42240, v29
    v_add_u32 v24, 42240, v24
    v_add_u32 v25, 42240, v25
    v_add_u32 v31, 42240, v31
    ds_write_b128 v29, v[56:59] offset:0
    s_waitcnt lgkmcnt(12)
    ds_write_b128 v29, v[60:63] offset:1024
    ds_write_b128 v29, v[64:67] offset:2048
    ds_write_b128 v29, v[68:71] offset:3072
    s_waitcnt lgkmcnt(12)
    ds_write_b128 v29, v[96:99] offset:16384
    ds_write_b128 v29, v[100:103] offset:17408
    ds_write_b128 v29, v[104:107] offset:18432
    s_waitcnt lgkmcnt(12)
    ds_write_b128 v29, v[108:111] offset:19456
    ds_write_b128 v29, a[96:99] offset:32768
    ds_write_b128 v29, a[100:103] offset:33792
    s_waitcnt lgkmcnt(12)
    ds_write_b128 v29, a[104:107] offset:34816
    ds_write_b128 v29, a[108:111] offset:35840
    ds_add_u32 v18, v19
    s_waitcnt lgkmcnt(12)
    ds_read_b32 v20, v0 offset:0
    s_waitcnt lgkmcnt(0)
    v_cmp_gt_u32 vcc, s56, v20
    s_cbranch_vccnz L_chk61
L_chk61_x:
    s_add_u32 s56, s56, 1
    ds_read_b128 v[56:59], v24 offset:0
    ds_read_b128 v[60:63], v24 offset:1024
    ds_read_b128 v[64:67], v24 offset:2048
    ds_read_b128 v[68:71], v24 offset:3072
    ds_read_b128 v[72:75], v25 offset:16384
    ds_read_b128 v[76:79], v25 offset:17408
    ds_read_b128 v[80:83], v25 offset:18432
    ds_read_b128 v[84:87], v25 offset:19456
    ds_read_b128 v[88:91], v31 offset:32768
    ds_read_b128 v[92:95], v31 offset:33792
    ds_read_b128 v[96:99], v31 offset:34816
    ds_read_b128 v[100:103], v31 offset:35840
    v_lshlrev_b32 v120, 16, v136
    v_and_b32 v121, 0xffff0000, v136
    v_lshlrev_b32 v122, 16, v137
    v_and_b32 v123, 0xffff0000, v137
    v_lshlrev_b32 v124, 16, v138
    v_and_b32 v125, 0xffff0000, v138
    v_lshlrev_b32 v126, 16, v139
    v_and_b32 v127, 0xffff0000, v139
    v_lshlrev_b32 v32, 16, v140
    v_and_b32 v33, 0xffff0000, v140
    v_lshlrev_b32 v34, 16, v141
    v_and_b32 v35, 0xffff0000, v141
    v_lshlrev_b32 v36, 16, v142
    v_and_b32 v37, 0xffff0000, v142
    v_lshlrev_b32 v38, 16, v143
    v_and_b32 v39, 0xffff0000, v143
    s_waitcnt lgkmcnt(8)
    v_pk_add_f32 v[40:41], v[40:41], v[56:57]
    v_pk_add_f32 v[42:43], v[42:43], v[58:59]
    v_pk_add_f32 v[44:45], v[44:45], v[60:61]
    v_pk_add_f32 v[46:47], v[46:47], v[62:63]
    v_pk_add_f32 v[48:49], v[48:49], v[64:65]
    v_pk_add_f32 v[50:51], v[50:51], v[66:67]
    v_pk_add_f32 v[52:53], v[52:53], v[68:69]
    v_pk_add_f32 v[54:55], v[54:55], v[70:71]
    s_waitcnt lgkmcnt(0)
    v_pk_add_f32 v[72:73], v[72:73], v[88:89]
    v_pk_add_f32 v[74:75], v[74:75], v[90:91]
    v_pk_add_f32 v[76:77], v[76:77], v[92:93]
    v_pk_add_f32 v[78:79], v[78:79], v[94:95]
    v_pk_add_f32 v[80:81], v[80:81], v[96:97]
    v_pk_add_f32 v[82:83], v[82:83], v[98:99]
    v_pk_add_f32 v[84:85], v[84:85], v[100:101]
    v_pk_add_f32 v[86:87], v[86:87], v[102:103]
    v_pk_add_f32 v[128:129], v[40:41], v[72:73]
    v_pk_add_f32 v[130:131], v[42:43], v[74:75]
    v_pk_add_f32 v[132:133], v[44:45], v[76:77]
    v_pk_add_f32 v[134:135], v[46:47], v[78:79]
    v_pk_add_f32 v[136:137], v[48:49], v[80:81]
    v_pk_add_f32 v[138:139], v[50:51], v[82:83]
    v_pk_add_f32 v[140:141], v[52:53], v[84:85]
    v_pk_add_f32 v[142:143], v[54:55], v[86:87]
    buffer_load_dwordx4 v[56:59], v7, s[28:31], s7 offen offset:0 sc1
    v_pk_mul_f32 v[40:41], v[128:129], s[62:63]
    v_pk_mul_f32 v[42:43], v[130:131], s[62:63]
    v_pk_mul_f32 v[44:45], v[132:133], s[62:63]
    v_pk_mul_f32 v[46:47], v[134:135], s[62:63]
    buffer_load_dwordx4 v[60:63], v27, s[28:31], s7 offen offset:0 sc1
    v_pk_mul_f32 v[48:49], v[136:137], s[62:63]
    v_pk_mul_f32 v[50:51], v[138:139], s[62:63]
    v_pk_mul_f32 v[52:53], v[140:141], s[62:63]
    v_pk_mul_f32 v[54:55], v[142:143], s[62:63]
    buffer_load_dwordx4 v[64:67], v7, s[28:31], s7 offen offset:1024 sc1
    v_exp_f32 v40, v40
    v_exp_f32 v41, v41
    v_exp_f32 v42, v42
    v_exp_f32 v43, v43
    buffer_load_dwordx4 v[68:71], v27, s[28:31], s7 offen offset:1024 sc1
    v_exp_f32 v44, v44
    v_exp_f32 v45, v45
    v_exp_f32 v46, v46
    v_exp_f32 v47, v47
    buffer_load_dwordx4 v[72:75], v7, s[28:31], s7 offen offset:2048 sc1
    v_exp_f32 v48, v48
    v_exp_f32 v49, v49
    v_exp_f32 v50, v50
    v_exp_f32 v51, v51
    buffer_load_dwordx4 v[76:79], v27, s[28:31], s7 offen offset:2048 sc1
    v_exp_f32 v52, v52
    v_exp_f32 v53, v53
    v_exp_f32 v54, v54
    v_exp_f32 v55, v55
    buffer_load_dwordx4 v[80:83], v7, s[28:31], s7 offen offset:3072 sc1
    v_add_u32 v29, 49152, v29
    v_add_u32 v24, 49152, v24
    v_add_u32 v25, 49152, v25
    v_add_u32 v31, 49152, v31
    buffer_load_dwordx4 v[84:87], v27, s[28:31], s7 offen offset:3072 sc1
    v_pk_add_f32 v[40:41], v[40:41], 1.0 op_sel_hi:[1,0]
    v_pk_add_f32 v[42:43], v[42:43], 1.0 op_sel_hi:[1,0]
    v_pk_add_f32 v[44:45], v[44:45], 1.0 op_sel_hi:[1,0]
    v_pk_add_f32 v[46:47], v[46:47], 1.0 op_sel_hi:[1,0]
    buffer_load_dwordx4 v[88:91], v7, s[28:31], s6 offen offset:0 sc1
    v_pk_add_f32 v[48:49], v[48:49], 1.0 op_sel_hi:[1,0]
    v_pk_add_f32 v[50:51], v[50:51], 1.0 op_sel_hi:[1,0]
    v_pk_add_f32 v[52:53], v[52:53], 1.0 op_sel_hi:[1,0]
    v_pk_add_f32 v[54:55], v[54:55], 1.0 op_sel_hi:[1,0]
    buffer_load_dwordx4 v[92:95], v27, s[28:31], s6 offen offset:0 sc1
    v_rcp_f32 v40, v40
    v_rcp_f32 v41, v41
    v_rcp_f32 v42, v42
    v_rcp_f32 v43, v43
    buffer_load_dwordx4 v[96:99], v7, s[28:31], s6 offen offset:1024 sc1
    v_rcp_f32 v44, v44
    v_rcp_f32 v45, v45
    v_rcp_f32 v46, v46
    v_rcp_f32 v47, v47
    buffer_load_dwordx4 v[100:103], v27, s[28:31], s6 offen offset:1024 sc1
    v_rcp_f32 v48, v48
    v_rcp_f32 v49, v49
    v_rcp_f32 v50, v50
    v_rcp_f32 v51, v51
    buffer_load_dwordx4 v[104:107], v7, s[28:31], s6 offen offset:2048 sc1
    v_rcp_f32 v52, v52
    v_rcp_f32 v53, v53
    v_rcp_f32 v54, v54
    v_rcp_f32 v55, v55
    buffer_load_dwordx4 v[108:111], v27, s[28:31], s6 offen offset:2048 sc1
    s_nop 0
    v_pk_mul_f32 v[128:129], v[128:129], v[40:41]
    v_pk_mul_f32 v[130:131], v[130:131], v[42:43]
    v_pk_mul_f32 v[132:133], v[132:133], v[44:45]
    buffer_load_dwordx4 v[112:115], v7, s[28:31], s6 offen offset:3072 sc1
    v_pk_mul_f32 v[134:135], v[134:135], v[46:47]
    v_pk_mul_f32 v[136:137], v[136:137], v[48:49]
    v_pk_mul_f32 v[138:139], v[138:139], v[50:51]
    v_pk_mul_f32 v[140:141], v[140:141], v[52:53]
    buffer_load_dwordx4 v[116:119], v27, s[28:31], s6 offen offset:3072 sc1
    v_pk_mul_f32 v[142:143], v[142:143], v[54:55]
    s_waitcnt vmcnt(14)
    v_max3_u32 v5, v56, v57, v58
    v_max3_u32 v20, v59, v60, v61
    v_max3_u32 v5, v5, v62, v63
    v_max_u32 v5, v5, v20
    v_cmp_eq_u32 vcc, -1, v5
    s_cbranch_vccnz L_ofx
    v_mfma_f32_32x32x16_bf16 v[40:55], a[0:3], v[56:59], 0
    v_mfma_f32_32x32x16_bf16 a[64:79], a[0:3], v[60:63], 0
    v_mfma_f32_32x32x16_bf16 a[80:95], a[4:7], v[56:59], 0
    v_mfma_f32_32x32x16_bf16 a[96:111], a[4:7], v[60:63], 0
    s_bitset1_b32 s4, 0
    s_mov_b32 s5, 1
    s_waitcnt vmcnt(12)
    v_max3_u32 v5, v64, v65, v66
    v_max3_u32 v20, v67, v68, v69
    v_max3_u32 v5, v5, v70, v71
    v_max_u32 v5, v5, v20
    v_cmp_eq_u32 vcc, -1, v5
    s_cbranch_vccnz L_ofx
    v_mfma_f32_32x32x16_bf16 v[40:55], a[8:11], v[64:67], v[40:55]
    v_mfma_f32_32x32x16_bf16 a[64:79], a[8:11], v[68:71], a[64:79]
    v_mfma_f32_32x32x16_bf16 a[80:95], a[12:15], v[64:67], a[80:95]
    v_mfma_f32_32x32x16_bf16 a[96:111], a[12:15], v[68:71], a[96:111]
    s_bitset1_b32 s4, 1
    s_mov_b32 s5, 2
    s_waitcnt vmcnt(10)
    v_max3_u32 v5, v72, v73, v74
    v_max3_u32 v20, v75, v76, v77
    v_max3_u32 v5, v5, v78, v79
    v_max_u32 v5, v5, v20
    v_cmp_eq_u32 vcc, -1, v5
    s_cbranch_vccnz L_ofx
    v_mfma_f32_32x32x16_bf16 v[40:55], a[16:19], v[72:75], v[40:55]
    v_mfma_f32_32x32x16_bf16 a[64:79], a[16:19], v[76:79], a[64:79]
    v_mfma_f32_32x32x16_bf16 a[80:95], a[20:23], v[72:75], a[80:95]
    v_mfma_f32_32x32x16_bf16 a[96:111], a[20:23], v[76:79], a[96:111]
    s_bitset1_b32 s4, 2
    s_mov_b32 s5, 3
    s_waitcnt vmcnt(8)
    v_max3_u32 v5, v80, v81, v82
    v_max3_u32 v20, v83, v84, v85
    v_max3_u32 v5, v5, v86, v87
    v_max_u32 v5, v5, v20
    v_cmp_eq_u32 vcc, -1, v5
    s_cbranch_vccnz L_ofx
    v_mfma_f32_32x32x16_bf16 v[40:55], a[24:27], v[80:83], v[40:55]
    v_mfma_f32_32x32x16_bf16 a[64:79], a[24:27], v[84:87], a[64:79]
    v_mfma_f32_32x32x16_bf16 a[80:95], a[28:31], v[80:83], a[80:95]
    v_mfma_f32_32x32x16_bf16 a[96:111], a[28:31], v[84:87], a[96:111]
    s_bitset1_b32 s4, 3
    s_mov_b32 s5, 4
    s_waitcnt vmcnt(6)
    v_max3_u32 v5, v88, v89, v90
    v_max3_u32 v20, v91, v92, v93
    v_max3_u32 v5, v5, v94, v95
    v_max_u32 v5, v5, v20
    v_cmp_eq_u32 vcc, -1, v5
    s_cbranch_vccnz L_ofx
    v_mfma_f32_32x32x16_bf16 v[40:55], a[32:35], v[88:91], v[40:55]
    v_mfma_f32_32x32x16_bf16 a[64:79], a[32:35], v[92:95], a[64:79]
    v_mfma_f32_32x32x16_bf16 a[80:95], a[36:39], v[88:91], a[80:95]
    v_mfma_f32_32x32x16_bf16 a[96:111], a[36:39], v[92:95], a[96:111]
    s_bitset1_b32 s4, 4
    s_mov_b32 s5, 5
    s_waitcnt vmcnt(4)
    v_max3_u32 v5, v96, v97, v98
    v_max3_u32 v20, v99, v100, v101
    v_max3_u32 v5, v5, v102, v103
    v_max_u32 v5, v5, v20
    v_cmp_eq_u32 vcc, -1, v5
    s_cbranch_vccnz L_ofx
    v_mfma_f32_32x32x16_bf16 v[40:55], a[40:43], v[96:99], v[40:55]
    v_mfma_f32_32x32x16_bf16 a[64:79], a[40:43], v[100:103], a[64:79]
    v_mfma_f32_32x32x16_bf16 a[80:95], a[44:47], v[96:99], a[80:95]
    v_mfma_f32_32x32x16_bf16 a[96:111], a[44:47], v[100:103], a[96:111]
    s_bitset1_b32 s4, 5
    s_mov_b32 s5, 6
    s_waitcnt vmcnt(2)
    v_max3_u32 v5, v104, v105, v106
    v_max3_u32 v20, v107, v108, v109
    v_max3_u32 v5, v5, v110, v111
    v_max_u32 v5, v5, v20
    v_cmp_eq_u32 vcc, -1, v5
    s_cbranch_vccnz L_ofx
    v_mfma_f32_32x32x16_bf16 v[40:55], a[48:51], v[104:107], v[40:55]
    v_mfma_f32_32x32x16_bf16 a[64:79], a[48:51], v[108:111], a[64:79]
    v_mfma_f32_32x32x16_bf16 a[80:95], a[52:55], v[104:107], a[80:95]
    v_mfma_f32_32x32x16_bf16 a[96:111], a[52:55], v[108:111], a[96:111]
    s_bitset1_b32 s4, 6
    s_mov_b32 s5, 7
    s_waitcnt vmcnt(0)
    v_max3_u32 v5, v112, v113, v114
    v_max3_u32 v20, v115, v116, v117
    v_max3_u32 v5, v5, v118, v119
    v_max_u32 v5, v5, v20
    v_cmp_eq_u32 vcc, -1, v5
    s_cbranch_vccnz L_ofx
    v_mfma_f32_32x32x16_bf16 v[40:55], a[56:59], v[112:115], v[40:55]
    v_mfma_f32_32x32x16_bf16 a[64:79], a[56:59], v[116:119], a[64:79]
    v_mfma_f32_32x32x16_bf16 a[80:95], a[60:63], v[112:115], a[80:95]
    v_mfma_f32_32x32x16_bf16 a[96:111], a[60:63], v[116:119], a[96:111]
    s_bitset1_b32 s4, 7
    s_mov_b32 s5, 8
L_odone:
    s_nop 10
    ds_write_b128 v29, a[64:67] offset:0
    ds_write_b128 v29, a[68:71] offset:1024
    ds_write_b128 v29, a[72:75] offset:2048
    ds_write_b128 v29, a[76:79] offset:3072
    ds_write_b128 v29, a[80:83] offset:16384
    ds_write_b128 v29, a[84:87] offset:17408
    ds_write_b128 v29, a[88:91] offset:18432
    ds_write_b128 v29, a[92:95] offset:19456
    ds_write_b128 v29, a[96:99] offset:32768
    ds_write_b128 v29, a[100:103] offset:33792
    ds_write_b128 v29, a[104:107] offset:34816
    ds_write_b128 v29, a[108:111] offset:35840
    ds_add_u32 v18, v19
    ds_read_b32 v20, v0 offset:0
    s_waitcnt lgkmcnt(0)
    v_cmp_gt_u32 vcc, s56, v20
    s_cbranch_vccnz L_chk62
L_chk62_x:
    s_add_u32 s56, s56, 1
    ds_read_b128 v[56:59], v24 offset:0
    ds_read_b128 v[60:63], v24 offset:1024
    ds_read_b128 v[64:67], v24 offset:2048
    ds_read_b128 v[68:71], v24 offset:3072
    ds_read_b128 v[72:75], v25 offset:16384
    ds_read_b128 v[76:79], v25 offset:17408
    ds_read_b128 v[80:83], v25 offset:18432
    ds_read_b128 v[84:87], v25 offset:19456
    ds_read_b128 v[88:91], v31 offset:32768
    ds_read_b128 v[92:95], v31 offset:33792
    ds_read_b128 v[96:99], v31 offset:34816
    ds_read_b128 v[100:103], v31 offset:35840
    s_waitcnt lgkmcnt(8)
    v_pk_add_f32 v[40:41], v[40:41], v[56:57]
    v_pk_add_f32 v[42:43], v[42:43], v[58:59]
    v_pk_add_f32 v[44:45], v[44:45], v[60:61]
    v_pk_add_f32 v[46:47], v[46:47], v[62:63]
    v_pk_add_f32 v[48:49], v[48:49], v[64:65]
    v_pk_add_f32 v[50:51], v[50:51], v[66:67]
    v_pk_add_f32 v[52:53], v[52:53], v[68:69]
    v_pk_add_f32 v[54:55], v[54:55], v[70:71]
    s_waitcnt lgkmcnt(0)
    v_pk_add_f32 v[72:73], v[72:73], v[88:89]
    v_pk_add_f32 v[74:75], v[74:75], v[90:91]
    v_pk_add_f32 v[76:77], v[76:77], v[92:93]
    v_pk_add_f32 v[78:79], v[78:79], v[94:95]
    v_pk_add_f32 v[80:81], v[80:81], v[96:97]
    v_pk_add_f32 v[82:83], v[82:83], v[98:99]
    v_pk_add_f32 v[84:85], v[84:85], v[100:101]
    v_pk_add_f32 v[86:87], v[86:87], v[102:103]
    v_pk_add_f32 v[40:41], v[40:41], v[72:73]
    v_pk_add_f32 v[42:43], v[42:43], v[74:75]
    v_pk_add_f32 v[44:45], v[44:45], v[76:77]
    v_pk_add_f32 v[46:47], v[46:47], v[78:79]
    v_pk_add_f32 v[48:49], v[48:49], v[80:81]
    v_pk_add_f32 v[50:51], v[50:51], v[82:83]
    v_pk_add_f32 v[52:53], v[52:53], v[84:85]
    v_pk_add_f32 v[54:55], v[54:55], v[86:87]
    v_pk_fma_f32 v[40:41], v[40:41], v[128:129], v[120:121]
    v_pk_fma_f32 v[42:43], v[42:43], v[130:131], v[122:123]
    v_pk_fma_f32 v[44:45], v[44:45], v[132:133], v[124:125]
    v_pk_fma_f32 v[46:47], v[46:47], v[134:135], v[126:127]
    v_pk_fma_f32 v[48:49], v[48:49], v[136:137], v[32:33]
    v_pk_fma_f32 v[50:51], v[50:51], v[138:139], v[34:35]
    v_pk_fma_f32 v[52:53], v[52:53], v[140:141], v[36:37]
    v_pk_fma_f32 v[54:55], v[54:55], v[142:143], v[38:39]
    v_cvt_pk_bf16_f32 v56, v40, v41
    v_cvt_pk_bf16_f32 v57, v42, v43
    v_cvt_pk_bf16_f32 v58, v44, v45
    v_cvt_pk_bf16_f32 v59, v46, v47
    v_cvt_pk_bf16_f32 v60, v48, v49
    v_cvt_pk_bf16_f32 v61, v50, v51
    v_cvt_pk_bf16_f32 v62, v52, v53
    v_cvt_pk_bf16_f32 v63, v54, v55
    s_nop 1
    v_permlane32_swap_b32 v56, v58
    v_permlane32_swap_b32 v57, v59
    v_permlane32_swap_b32 v60, v62
    v_permlane32_swap_b32 v61, v63
    buffer_store_dwordx4 v[56:59], v30, s[32:35], s67 offen offset:0
    buffer_store_dwordx4 v[60:63], v30, s[32:35], s67 offen offset:32
    s_endpgm
L_chk1:
    ds_read_b32 v20, v0 offset:1024
    s_waitcnt lgkmcnt(0)
    v_cmp_gt_u32 vcc, 3, v20
    s_cbranch_vccz L_chk1_x
    s_sub_u32 s47, s47, 1
    s_cmp_lt_i32 s47, 0
    s_cbranch_scc1 L_chk1_x
    s_branch L_chk1
L_chk2:
    ds_read_b32 v20, v0 offset:1024
    s_waitcnt lgkmcnt(0)
    v_cmp_gt_u32 vcc, 4, v20
    s_cbranch_vccz L_chk2_x
    s_sub_u32 s47, s47, 1
    s_cmp_lt_i32 s47, 0
    s_cbranch_scc1 L_chk2_x
    s_branch L_chk2
L_chk3:
    ds_read_b32 v20, v0 offset:1024
    s_waitcnt lgkmcnt(0)
    v_cmp_gt_u32 vcc, 5, v20
    s_cbranch_vccz L_chk3_x
    s_sub_u32 s47, s47, 1
    s_cmp_lt_i32 s47, 0
    s_cbranch_scc1 L_chk3_x
    s_branch L_chk3
L_chk4:
    ds_read_b32 v20, v0 offset:1024
    s_waitcnt lgkmcnt(0)
    v_cmp_gt_u32 vcc, 6, v20
    s_cbranch_vccz L_chk4_x
    s_sub_u32 s47, s47, 1
    s_cmp_lt_i32 s47, 0
    s_cbranch_scc1 L_chk4_x
    s_branch L_chk4
L_chk5:
    ds_read_b32 v20, v0 offset:1024
    s_waitcnt lgkmcnt(0)
    v_cmp_gt_u32 vcc, 7, v20
    s_cbranch_vccz L_chk5_x
    s_sub_u32 s47, s47, 1
    s_cmp_lt_i32 s47, 0
    s_cbranch_scc1 L_chk5_x
    s_branch L_chk5
L_chk6:
    ds_read_b32 v20, v0 offset:1024
    s_waitcnt lgkmcnt(0)
    v_cmp_gt_u32 vcc, 8, v20
    s_cbranch_vccz L_chk6_x
    s_sub_u32 s47, s47, 1
    s_cmp_lt_i32 s47, 0
    s_cbranch_scc1 L_chk6_x
    s_branch L_chk6
L_chk7:
    ds_read_b32 v20, v0 offset:1024
    s_waitcnt lgkmcnt(0)
    v_cmp_gt_u32 vcc, 9, v20
    s_cbranch_vccz L_chk7_x
    s_sub_u32 s47, s47, 1
    s_cmp_lt_i32 s47, 0
    s_cbranch_scc1 L_chk7_x
    s_branch L_chk7
L_chk8:
    ds_read_b32 v20, v0 offset:1024
    s_waitcnt lgkmcnt(0)
    v_cmp_gt_u32 vcc, 10, v20
    s_cbranch_vccz L_chk8_x
    s_sub_u32 s47, s47, 1
    s_cmp_lt_i32 s47, 0
    s_cbranch_scc1 L_chk8_x
    s_branch L_chk8
L_chk9:
    ds_read_b32 v20, v0 offset:1024
    s_waitcnt lgkmcnt(0)
    v_cmp_gt_u32 vcc, 11, v20
    s_cbranch_vccz L_chk9_x
    s_sub_u32 s47, s47, 1
    s_cmp_lt_i32 s47, 0
    s_cbranch_scc1 L_chk9_x
    s_branch L_chk9
L_chk10:
    ds_read_b32 v20, v0 offset:1024
    s_waitcnt lgkmcnt(0)
    v_cmp_gt_u32 vcc, 12, v20
    s_cbranch_vccz L_chk10_x
    s_sub_u32 s47, s47, 1
    s_cmp_lt_i32 s47, 0
    s_cbranch_scc1 L_chk10_x
    s_branch L_chk10
L_chk11:
    ds_read_b32 v20, v0 offset:1024
    s_waitcnt lgkmcnt(0)
    v_cmp_gt_u32 vcc, 13, v20
    s_cbranch_vccz L_chk11_x
    s_sub_u32 s47, s47, 1
    s_cmp_lt_i32 s47, 0
    s_cbranch_scc1 L_chk11_x
    s_branch L_chk11
L_chk12:
    ds_read_b32 v20, v0 offset:1024
    s_waitcnt lgkmcnt(0)
    s_setprio 3
    v_cmp_gt_u32 vcc, 14, v20
    s_setprio 0
    s_cbranch_vccz L_chk12_x
    s_sub_u32 s47, s47, 1
    s_cmp_lt_i32 s47, 0
    s_cbranch_scc1 L_chk12_x
    s_sleep 1
    s_branch L_chk12
L_chk13:
    ds_read_b32 v20, v0 offset:0
    s_waitcnt lgkmcnt(0)
    s_setprio 3
    v_cmp_gt_u32 vcc, 12, v20
    s_setprio 0
    s_cbranch_vccz L_chk13_x
    s_sub_u32 s47, s47, 1
    s_cmp_lt_i32 s47, 0
    s_cbranch_scc1 L_chk13_x
    s_sleep 1
    s_branch L_chk13
L_chk14:
    ds_read_b32 v25, v0 offset:1024
    s_waitcnt lgkmcnt(0)
    s_setprio 3
    v_cmp_gt_u32 vcc, 15, v25
    s_setprio 0
    s_cbranch_vccz L_chk14_x
    s_sub_u32 s47, s47, 1
    s_cmp_lt_i32 s47, 0
    s_cbranch_scc1 L_chk14_x
    s_sleep 4
    s_branch L_chk14
L_chk15:
    ds_read_b32 v25, v0 offset:1024
    s_waitcnt lgkmcnt(0)
    s_setprio 3
    v_cmp_gt_u32 vcc, 16, v25
    s_setprio 0
    s_cbranch_vccz L_chk15_x
    s_sub_u32 s47, s47, 1
    s_cmp_lt_i32 s47, 0
    s_cbranch_scc1 L_chk15_x
    s_sleep 4
    s_branch L_chk15
L_chk16:
    ds_read_b32 v25, v0 offset:1024
    s_waitcnt lgkmcnt(0)
    s_setprio 3
    v_cmp_gt_u32 vcc, 17, v25
    s_setprio 0
    s_cbranch_vccz L_chk16_x
    s_sub_u32 s47, s47, 1
    s_cmp_lt_i32 s47, 0
    s_cbranch_scc1 L_chk16_x
    s_sleep 4
    s_branch L_chk16
L_chk17:
    ds_read_b32 v25, v0 offset:1024
    s_waitcnt lgkmcnt(0)
    s_setprio 3
    v_cmp_gt_u32 vcc, 17, v25
    s_setprio 0
    s_cbranch_vccz L_chk17_x
    s_sub_u32 s47, s47, 1
    s_cmp_lt_i32 s47, 0
    s_cbranch_scc1 L_chk17_x
    s_sleep 4
    s_branch L_chk17
L_chk18:
    ds_read_b32 v20, v0 offset:0
    s_waitcnt lgkmcnt(0)
    s_setprio 3
    v_cmp_gt_u32 vcc, s56, v20
    s_setprio 0
    s_cbranch_vccz L_chk18_x
    s_sub_u32 s47, s47, 1
    s_cmp_lt_i32 s47, 0
    s_cbranch_scc1 L_chk18_x
    s_sleep 1
    s_branch L_chk18
L_chk19:
    ds_read_b32 v20, v0 offset:0
    s_waitcnt lgkmcnt(0)
    s_setprio 3
    v_cmp_gt_u32 vcc, s56, v20
    s_setprio 0
    s_cbranch_vccz L_chk19_x
    s_sub_u32 s47, s47, 1
    s_cmp_lt_i32 s47, 0
    s_cbranch_scc1 L_chk19_x
    s_sleep 1
    s_branch L_chk19
L_chk20:
    ds_read_b32 v20, v0 offset:0
    s_waitcnt lgkmcnt(0)
    s_setprio 3
    v_cmp_gt_u32 vcc, s56, v20
    s_setprio 0
    s_cbranch_vccz L_chk20_x
    s_sub_u32 s47, s47, 1
    s_cmp_lt_i32 s47, 0
    s_cbranch_scc1 L_chk20_x
    s_sleep 1
    s_branch L_chk20
L_chk21:
    ds_read_b32 v20, v0 offset:0
    s_waitcnt lgkmcnt(0)
    s_setprio 3
    v_cmp_gt_u32 vcc, s56, v20
    s_setprio 0
    s_cbranch_vccz L_chk21_x
    s_sub_u32 s47, s47, 1
    s_cmp_lt_i32 s47, 0
    s_cbranch_scc1 L_chk21_x
    s_sleep 1
    s_branch L_chk21
L_chk22:
    ds_read_b32 v20, v0 offset:1024
    s_waitcnt lgkmcnt(0)
    s_setprio 3
    v_cmp_gt_u32 vcc, 14, v20
    s_setprio 0
    s_cbranch_vccz L_chk22_x
    s_sub_u32 s47, s47, 1
    s_cmp_lt_i32 s47, 0
    s_cbranch_scc1 L_chk22_x
    s_sleep 1
    s_branch L_chk22
L_chk23:
    ds_read_b32 v20, v0 offset:0
    s_waitcnt lgkmcnt(0)
    s_setprio 3
    v_cmp_gt_u32 vcc, s56, v20
    s_setprio 0
    s_cbranch_vccz L_chk23_x
    s_sub_u32 s47, s47, 1
    s_cmp_lt_i32 s47, 0
    s_cbranch_scc1 L_chk23_x
    s_sleep 1
    s_branch L_chk23
L_chk24:
    ds_read_b32 v25, v0 offset:1024
    s_waitcnt lgkmcnt(0)
    s_setprio 3
    v_cmp_gt_u32 vcc, 15, v25
    s_setprio 0
    s_cbranch_vccz L_chk24_x
    s_sub_u32 s47, s47, 1
    s_cmp_lt_i32 s47, 0
    s_cbranch_scc1 L_chk24_x
    s_sleep 4
    s_branch L_chk24
L_chk25:
    ds_read_b32 v20, v0 offset:0
    s_waitcnt lgkmcnt(0)
    s_setprio 3
    v_cmp_gt_u32 vcc, s56, v20
    s_setprio 0
    s_cbranch_vccz L_chk25_x
    s_sub_u32 s47, s47, 1
    s_cmp_lt_i32 s47, 0
    s_cbranch_scc1 L_chk25_x
    s_sleep 1
    s_branch L_chk25
L_chk26:
    ds_read_b32 v25, v0 offset:1024
    s_waitcnt lgkmcnt(0)
    s_setprio 3
    v_cmp_gt_u32 vcc, 16, v25
    s_setprio 0
    s_cbranch_vccz L_chk26_x
    s_sub_u32 s47, s47, 1
    s_cmp_lt_i32 s47, 0
    s_cbranch_scc1 L_chk26_x
    s_sleep 4
    s_branch L_chk26
L_chk27:
    ds_read_b32 v20, v0 offset:0
    s_waitcnt lgkmcnt(0)
    s_setprio 3
    v_cmp_gt_u32 vcc, s56, v20
    s_setprio 0
    s_cbranch_vccz L_chk27_x
    s_sub_u32 s47, s47, 1
    s_cmp_lt_i32 s47, 0
    s_cbranch_scc1 L_chk27_x
    s_sleep 1
    s_branch L_chk27
L_chk28:
    ds_read_b32 v25, v0 offset:1024
    s_waitcnt lgkmcnt(0)
    s_setprio 3
    v_cmp_gt_u32 vcc, 17, v25
    s_setprio 0
    s_cbranch_vccz L_chk28_x
    s_sub_u32 s47, s47, 1
    s_cmp_lt_i32 s47, 0
    s_cbranch_scc1 L_chk28_x
    s_sleep 4
    s_branch L_chk28
L_chk29:
    ds_read_b32 v20, v0 offset:0
    s_waitcnt lgkmcnt(0)
    s_setprio 3
    v_cmp_gt_u32 vcc, s56, v20
    s_setprio 0
    s_cbranch_vccz L_chk29_x
    s_sub_u32 s47, s47, 1
    s_cmp_lt_i32 s47, 0
    s_cbranch_scc1 L_chk29_x
    s_sleep 1
    s_branch L_chk29
L_chk30:
    ds_read_b32 v20, v0 offset:0
    s_waitcnt lgkmcnt(0)
    s_setprio 3
    v_cmp_gt_u32 vcc, s56, v20
    s_setprio 0
    s_cbranch_vccz L_chk30_x
    s_sub_u32 s47, s47, 1
    s_cmp_lt_i32 s47, 0
    s_cbranch_scc1 L_chk30_x
    s_sleep 1
    s_branch L_chk30
L_chk31:
    ds_read_b32 v25, v0 offset:1024
    s_waitcnt lgkmcnt(0)
    s_setprio 3
    v_cmp_gt_u32 vcc, 18, v25
    s_setprio 0
    s_cbranch_vccz L_chk31_x
    s_sub_u32 s47, s47, 1
    s_cmp_lt_i32 s47, 0
    s_cbranch_scc1 L_chk31_x
    s_sleep 4
    s_branch L_chk31
L_chk32:
    ds_read_b32 v20, v0 offset:0
    s_waitcnt lgkmcnt(0)
    s_setprio 3
    v_cmp_gt_u32 vcc, s56, v20
    s_setprio 0
    s_cbranch_vccz L_chk32_x
    s_sub_u32 s47, s47, 1
    s_cmp_lt_i32 s47, 0
    s_cbranch_scc1 L_chk32_x
    s_sleep 1
    s_branch L_chk32
L_chk33:
    ds_read_b32 v20, v0 offset:0
    s_waitcnt lgkmcnt(0)
    s_setprio 3
    v_cmp_gt_u32 vcc, s56, v20
    s_setprio 0
    s_cbranch_vccz L_chk33_x
    s_sub_u32 s47, s47, 1
    s_cmp_lt_i32 s47, 0
    s_cbranch_scc1 L_chk33_x
    s_sleep 1
    s_branch L_chk33
L_chk35:
    ds_read_b32 v25, v0 offset:1024
    s_waitcnt lgkmcnt(0)
    s_setprio 3
    v_cmp_gt_u32 vcc, 19, v25
    s_setprio 0
    s_cbranch_vccz L_chk35_x
    s_sub_u32 s47, s47, 1
    s_cmp_lt_i32 s47, 0
    s_cbranch_scc1 L_chk35_x
    s_sleep 4
    s_branch L_chk35
L_chk36:
    ds_read_b32 v20, v0 offset:0
    s_waitcnt lgkmcnt(0)
    s_setprio 3
    v_cmp_gt_u32 vcc, s56, v20
    s_setprio 0
    s_cbranch_vccz L_chk36_x
    s_sub_u32 s47, s47, 1
    s_cmp_lt_i32 s47, 0
    s_cbranch_scc1 L_chk36_x
    s_sleep 1
    s_branch L_chk36
L_chk37:
    ds_read_b32 v20, v0 offset:0
    s_waitcnt lgkmcnt(0)
    s_setprio 3
    v_cmp_gt_u32 vcc, s56, v20
    s_setprio 0
    s_cbranch_vccz L_chk37_x
    s_sub_u32 s47, s47, 1
    s_cmp_lt_i32 s47, 0
    s_cbranch_scc1 L_chk37_x
    s_sleep 1
    s_branch L_chk37
L_chk38:
    ds_read_b32 v25, v0 offset:1024
    s_waitcnt lgkmcnt(0)
    s_setprio 3
    v_cmp_gt_u32 vcc, 20, v25
    s_setprio 0
    s_cbranch_vccz L_chk38_x
    s_sub_u32 s47, s47, 1
    s_cmp_lt_i32 s47, 0
    s_cbranch_scc1 L_chk38_x
    s_sleep 4
    s_branch L_chk38
L_chk39:
    ds_read_b32 v20, v0 offset:0
    s_waitcnt lgkmcnt(0)
    s_setprio 3
    v_cmp_gt_u32 vcc, s56, v20
    s_setprio 0
    s_cbranch_vccz L_chk39_x
    s_sub_u32 s47, s47, 1
    s_cmp_lt_i32 s47, 0
    s_cbranch_scc1 L_chk39_x
    s_sleep 1
    s_branch L_chk39
L_chk40:
    ds_read_b32 v20, v0 offset:0
    s_waitcnt lgkmcnt(0)
    s_setprio 3
    v_cmp_gt_u32 vcc, s56, v20
    s_setprio 0
    s_cbranch_vccz L_chk40_x
    s_sub_u32 s47, s47, 1
    s_cmp_lt_i32 s47, 0
    s_cbranch_scc1 L_chk40_x
    s_sleep 1
    s_branch L_chk40
L_chk41:
    ds_read_b32 v25, v0 offset:1024
    s_waitcnt lgkmcnt(0)
    s_setprio 3
    v_cmp_gt_u32 vcc, 21, v25
    s_setprio 0
    s_cbranch_vccz L_chk41_x
    s_sub_u32 s47, s47, 1
    s_cmp_lt_i32 s47, 0
    s_cbranch_scc1 L_chk41_x
    s_sleep 4
    s_branch L_chk41
L_chk42:
    ds_read_b32 v20, v0 offset:0
    s_waitcnt lgkmcnt(0)
    s_setprio 3
    v_cmp_gt_u32 vcc, s56, v20
    s_setprio 0
    s_cbranch_vccz L_chk42_x
    s_sub_u32 s47, s47, 1
    s_cmp_lt_i32 s47, 0
    s_cbranch_scc1 L_chk42_x
    s_sleep 1
    s_branch L_chk42
L_chk43:
    ds_read_b32 v20, v0 offset:0
    s_waitcnt lgkmcnt(0)
    s_setprio 3
    v_cmp_gt_u32 vcc, s56, v20
    s_setprio 0
    s_cbranch_vccz L_chk43_x
    s_sub_u32 s47, s47, 1
    s_cmp_lt_i32 s47, 0
    s_cbranch_scc1 L_chk43_x
    s_sleep 1
    s_branch L_chk43
L_chk44:
    ds_read_b32 v25, v0 offset:1024
    s_waitcnt lgkmcnt(0)
    s_setprio 3
    v_cmp_gt_u32 vcc, 22, v25
    s_setprio 0
    s_cbranch_vccz L_chk44_x
    s_sub_u32 s47, s47, 1
    s_cmp_lt_i32 s47, 0
    s_cbranch_scc1 L_chk44_x
    s_sleep 4
    s_branch L_chk44
L_chk45:
    ds_read_b32 v20, v0 offset:0
    s_waitcnt lgkmcnt(0)
    s_setprio 3
    v_cmp_gt_u32 vcc, s56, v20
    s_setprio 0
    s_cbranch_vccz L_chk45_x
    s_sub_u32 s47, s47, 1
    s_cmp_lt_i32 s47, 0
    s_cbranch_scc1 L_chk45_x
    s_sleep 1
    s_branch L_chk45
L_chk46:
    ds_read_b32 v20, v0 offset:0
    s_waitcnt lgkmcnt(0)
    s_setprio 3
    v_cmp_gt_u32 vcc, s56, v20
    s_setprio 0
    s_cbranch_vccz L_chk46_x
    s_sub_u32 s47, s47, 1
    s_cmp_lt_i32 s47, 0
    s_cbranch_scc1 L_chk46_x
    s_sleep 1
    s_branch L_chk46
L_chk48:
    ds_read_b32 v25, v0 offset:1024
    s_waitcnt lgkmcnt(0)
    s_setprio 3
    v_cmp_gt_u32 vcc, 23, v25
    s_setprio 0
    s_cbranch_vccz L_chk48_x
    s_sub_u32 s47, s47, 1
    s_cmp_lt_i32 s47, 0
    s_cbranch_scc1 L_chk48_x
    s_sleep 4
    s_branch L_chk48
L_chk49:
    ds_read_b32 v20, v0 offset:0
    s_waitcnt lgkmcnt(0)
    s_setprio 3
    v_cmp_gt_u32 vcc, s56, v20
    s_setprio 0
    s_cbranch_vccz L_chk49_x
    s_sub_u32 s47, s47, 1
    s_cmp_lt_i32 s47, 0
    s_cbranch_scc1 L_chk49_x
    s_sleep 1
    s_branch L_chk49
L_chk50:
    ds_read_b32 v20, v0 offset:0
    s_waitcnt lgkmcnt(0)
    s_setprio 3
    v_cmp_gt_u32 vcc, s56, v20
    s_setprio 0
    s_cbranch_vccz L_chk50_x
    s_sub_u32 s47, s47, 1
    s_cmp_lt_i32 s47, 0
    s_cbranch_scc1 L_chk50_x
    s_sleep 1
    s_branch L_chk50
L_chk51:
    ds_read_b32 v25, v0 offset:1024
    s_waitcnt lgkmcnt(0)
    s_setprio 3
    v_cmp_gt_u32 vcc, 24, v25
    s_setprio 0
    s_cbranch_vccz L_chk51_x
    s_sub_u32 s47, s47, 1
    s_cmp_lt_i32 s47, 0
    s_cbranch_scc1 L_chk51_x
    s_sleep 4
    s_branch L_chk51
L_fo_s:
    s_lshl_b32 s45, s41, 12
    s_lshl_b32 s43, s48, 10
    s_add_u32 s45, s45, s43
    s_add_u32 s45, s45, 25821184
    s_setprio 3
L_fo:
    s_mov_b64 exec, 0xff
    buffer_load_dword v5, v23, s[28:31], s45 offen sc1
    s_waitcnt vmcnt(0)
    v_cmp_ne_u32 vcc, s46, v5
    s_mov_b64 exec, -1
    s_cbranch_vccz L_fo_x
    s_sub_u32 s47, s47, 1
    s_cmp_lt_i32 s47, 0
    s_cbranch_scc1 L_fo_x
    s_sleep 8
    s_branch L_fo
L_fo_x:
    s_setprio 0
    s_branch L_fo_b
L_chk52:
    ds_read_b32 v20, v0 offset:0
    s_waitcnt lgkmcnt(0)
    s_setprio 3
    v_cmp_gt_u32 vcc, s56, v20
    s_setprio 0
    s_cbranch_vccz L_chk52_x
    s_sub_u32 s47, s47, 1
    s_cmp_lt_i32 s47, 0
    s_cbranch_scc1 L_chk52_x
    s_sleep 1
    s_branch L_chk52
L_chk53:
    ds_read_b32 v20, v0 offset:0
    s_waitcnt lgkmcnt(0)
    s_setprio 3
    v_cmp_gt_u32 vcc, s56, v20
    s_setprio 0
    s_cbranch_vccz L_chk53_x
    s_sub_u32 s47, s47, 1
    s_cmp_lt_i32 s47, 0
    s_cbranch_scc1 L_chk53_x
    s_sleep 1
    s_branch L_chk53
L_chk54:
    ds_read_b32 v25, v0 offset:1024
    s_waitcnt lgkmcnt(0)
    s_setprio 3
    v_cmp_gt_u32 vcc, 25, v25
    s_setprio 0
    s_cbranch_vccz L_chk54_x
    s_sub_u32 s47, s47, 1
    s_cmp_lt_i32 s47, 0
    s_cbranch_scc1 L_chk54_x
    s_sleep 4
    s_branch L_chk54
L_chk55:
    ds_read_b32 v20, v0 offset:0
    s_waitcnt lgkmcnt(0)
    s_setprio 3
    v_cmp_gt_u32 vcc, s56, v20
    s_setprio 0
    s_cbranch_vccz L_chk55_x
    s_sub_u32 s47, s47, 1
    s_cmp_lt_i32 s47, 0
    s_cbranch_scc1 L_chk55_x
    s_sleep 1
    s_branch L_chk55
L_hf0_s:
    s_add_u32 s45, s66, 0
    s_setprio 3
L_hf0:
    s_mov_b64 exec, 0xfff0fff
    buffer_load_dword v5, v23, s[28:31], s45 offen sc1
    s_waitcnt vmcnt(0)
    v_cmp_ne_u32 vcc, s46, v5
    s_mov_b64 exec, -1
    s_cbranch_vccz L_hf0_x
    s_sub_u32 s47, s47, 1
    s_cmp_lt_i32 s47, 0
    s_cbranch_scc1 L_hf0_x
    s_sleep 8
    s_branch L_hf0
L_hf0_x:
    s_setprio 0
    s_branch L_hf0_b
L_chk56:
    ds_read_b32 v20, v0 offset:0
    s_waitcnt lgkmcnt(0)
    s_setprio 3
    v_cmp_gt_u32 vcc, s56, v20
    s_setprio 0
    s_cbranch_vccz L_chk56_x
    s_sub_u32 s47, s47, 1
    s_cmp_lt_i32 s47, 0
    s_cbranch_scc1 L_chk56_x
    s_sleep 1
    s_branch L_chk56
L_chk57:
    ds_read_b32 v25, v0 offset:1024
    s_waitcnt lgkmcnt(0)
    s_setprio 3
    v_cmp_gt_u32 vcc, 26, v25
    s_setprio 0
    s_cbranch_vccz L_chk57_x
    s_sub_u32 s47, s47, 1
    s_cmp_lt_i32 s47, 0
    s_cbranch_scc1 L_chk57_x
    s_sleep 4
    s_branch L_chk57
L_chk58:
    ds_read_b32 v20, v0 offset:0
    s_waitcnt lgkmcnt(0)
    s_setprio 3
    v_cmp_gt_u32 vcc, s56, v20
    s_setprio 0
    s_cbranch_vccz L_chk58_x
    s_sub_u32 s47, s47, 1
    s_cmp_lt_i32 s47, 0
    s_cbranch_scc1 L_chk58_x
    s_sleep 1
    s_branch L_chk58
L_hf1_s:
    s_add_u32 s45, s66, 4096
    s_setprio 3
L_hf1:
    s_mov_b64 exec, 0xffffffff
    buffer_load_dword v5, v23, s[28:31], s45 offen sc1
    s_waitcnt vmcnt(0)
    v_cmp_ne_u32 vcc, s46, v5
    s_mov_b64 exec, -1
    s_cbranch_vccz L_hf1_x
    s_sub_u32 s47, s47, 1
    s_cmp_lt_i32 s47, 0
    s_cbranch_scc1 L_hf1_x
    s_sleep 8
    s_branch L_hf1
L_hf1_x:
    s_setprio 0
    s_branch L_hf1_b
L_hf2_s:
    s_add_u32 s45, s66, 8192
    s_setprio 3
L_hf2:
    s_mov_b64 exec, 0xffffffff
    buffer_load_dword v5, v23, s[28:31], s45 offen sc1
    s_waitcnt vmcnt(0)
    v_cmp_ne_u32 vcc, s46, v5
    s_mov_b64 exec, -1
    s_cbranch_vccz L_hf2_x
    s_sub_u32 s47, s47, 1
    s_cmp_lt_i32 s47, 0
    s_cbranch_scc1 L_hf2_x
    s_sleep 8
    s_branch L_hf2
L_hf2_x:
    s_setprio 0
    s_branch L_hf2_b
L_chk60:
    ds_read_b32 v20, v0 offset:1024
    s_waitcnt lgkmcnt(0)
    s_setprio 3
    v_cmp_gt_u32 vcc, 30, v20
    s_setprio 0
    s_cbranch_vccz L_chk60_x
    s_sub_u32 s47, s47, 1
    s_cmp_lt_i32 s47, 0
    s_cbranch_scc1 L_chk60_x
    s_sleep 4
    s_branch L_chk60
L_chk61:
    ds_read_b32 v20, v0 offset:0
    s_waitcnt lgkmcnt(0)
    v_cmp_gt_u32 vcc, s56, v20
    s_cbranch_vccz L_chk61_x
    s_sub_u32 s47, s47, 1
    s_cmp_lt_i32 s47, 0
    s_cbranch_scc1 L_chk61_x
    s_branch L_chk61
L_ofx:
    s_andn2_b32 s64, 0xff, s4
L_of:
    s_waitcnt vmcnt(0)
    s_bitcmp1_b32 s64, 0
    s_cbranch_scc0 L_ov0
    v_max3_u32 v5, v56, v57, v58
    v_max3_u32 v20, v59, v60, v61
    v_max3_u32 v5, v5, v62, v63
    v_max_u32 v5, v5, v20
    v_cmp_eq_u32 vcc, -1, v5
    s_cbranch_vccnz L_ov0
    s_bitset1_b32 s4, 0
L_ov0:
    s_bitcmp1_b32 s64, 1
    s_cbranch_scc0 L_ov1
    v_max3_u32 v5, v64, v65, v66
    v_max3_u32 v20, v67, v68, v69
    v_max3_u32 v5, v5, v70, v71
    v_max_u32 v5, v5, v20
    v_cmp_eq_u32 vcc, -1, v5
    s_cbranch_vccnz L_ov1
    s_bitset1_b32 s4, 1
L_ov1:
    s_bitcmp1_b32 s64, 2
    s_cbranch_scc0 L_ov2
    v_max3_u32 v5, v72, v73, v74
    v_max3_u32 v20, v75, v76, v77
    v_max3_u32 v5, v5, v78, v79
    v_max_u32 v5, v5, v20
    v_cmp_eq_u32 vcc, -1, v5
    s_cbranch_vccnz L_ov2
    s_bitset1_b32 s4, 2
L_ov2:
    s_bitcmp1_b32 s64, 3
    s_cbranch_scc0 L_ov3
    v_max3_u32 v5, v80, v81, v82
    v_max3_u32 v20, v83, v84, v85
    v_max3_u32 v5, v5, v86, v87
    v_max_u32 v5, v5, v20
    v_cmp_eq_u32 vcc, -1, v5
    s_cbranch_vccnz L_ov3
    s_bitset1_b32 s4, 3
L_ov3:
    s_bitcmp1_b32 s64, 4
    s_cbranch_scc0 L_ov4
    v_max3_u32 v5, v88, v89, v90
    v_max3_u32 v20, v91, v92, v93
    v_max3_u32 v5, v5, v94, v95
    v_max_u32 v5, v5, v20
    v_cmp_eq_u32 vcc, -1, v5
    s_cbranch_vccnz L_ov4
    s_bitset1_b32 s4, 4
L_ov4:
    s_bitcmp1_b32 s64, 5
    s_cbranch_scc0 L_ov5
    v_max3_u32 v5, v96, v97, v98
    v_max3_u32 v20, v99, v100, v101
    v_max3_u32 v5, v5, v102, v103
    v_max_u32 v5, v5, v20
    v_cmp_eq_u32 vcc, -1, v5
    s_cbranch_vccnz L_ov5
    s_bitset1_b32 s4, 5
L_ov5:
    s_bitcmp1_b32 s64, 6
    s_cbranch_scc0 L_ov6
    v_max3_u32 v5, v104, v105, v106
    v_max3_u32 v20, v107, v108, v109
    v_max3_u32 v5, v5, v110, v111
    v_max_u32 v5, v5, v20
    v_cmp_eq_u32 vcc, -1, v5
    s_cbranch_vccnz L_ov6
    s_bitset1_b32 s4, 6
L_ov6:
    s_bitcmp1_b32 s64, 7
    s_cbranch_scc0 L_ov7
    v_max3_u32 v5, v112, v113, v114
    v_max3_u32 v20, v115, v116, v117
    v_max3_u32 v5, v5, v118, v119
    v_max_u32 v5, v5, v20
    v_cmp_eq_u32 vcc, -1, v5
    s_cbranch_vccnz L_ov7
    s_bitset1_b32 s4, 7
L_ov7:
    s_cmp_lt_i32 s47, 0
    s_cselect_b32 s4, 0xff, s4
    s_cmp_eq_u32 s4, 0xff
    s_cbranch_scc1 L_onp
    s_bcnt1_i32_b32 s65, s4
    s_cmp_ge_u32 s65, 4
    s_cbranch_scc1 L_odir
    s_mov_b64 exec, 0xffff
    buffer_load_dword v22, v23, s[28:31], s7 offen offset:1020 sc1
    s_mov_b64 exec, -1
    s_branch L_onp
L_odir:
    s_andn2_b32 s64, 0xff, s4
    s_sub_u32 s47, s47, 1
    s_bitcmp1_b32 s64, 0
    s_cbranch_scc0 L_olc_0
    buffer_load_dwordx4 v[56:59], v7, s[28:31], s7 offen offset:0 sc1
    buffer_load_dwordx4 v[60:63], v27, s[28:31], s7 offen offset:0 sc1
L_olc_0:
    s_bitcmp1_b32 s64, 1
    s_cbranch_scc0 L_olc_1
    buffer_load_dwordx4 v[64:67], v7, s[28:31], s7 offen offset:1024 sc1
    buffer_load_dwordx4 v[68:71], v27, s[28:31], s7 offen offset:1024 sc1
L_olc_1:
    s_bitcmp1_b32 s64, 2
    s_cbranch_scc0 L_olc_2
    buffer_load_dwordx4 v[72:75], v7, s[28:31], s7 offen offset:2048 sc1
    buffer_load_dwordx4 v[76:79], v27, s[28:31], s7 offen offset:2048 sc1
L_olc_2:
    s_bitcmp1_b32 s64, 3
    s_cbranch_scc0 L_olc_3
    buffer_load_dwordx4 v[80:83], v7, s[28:31], s7 offen offset:3072 sc1
    buffer_load_dwordx4 v[84:87], v27, s[28:31], s7 offen offset:3072 sc1
L_olc_3:
    s_bitcmp1_b32 s64, 4
    s_cbranch_scc0 L_olc_4
    buffer_load_dwordx4 v[88:91], v7, s[28:31], s6 offen offset:0 sc1
    buffer_load_dwordx4 v[92:95], v27, s[28:31], s6 offen offset:0 sc1
L_olc_4:
    s_bitcmp1_b32 s64, 5
    s_cbranch_scc0 L_olc_5
    buffer_load_dwordx4 v[96:99], v7, s[28:31], s6 offen offset:1024 sc1
    buffer_load_dwordx4 v[100:103], v27, s[28:31], s6 offen offset:1024 sc1
L_olc_5:
    s_bitcmp1_b32 s64, 6
    s_cbranch_scc0 L_olc_6
    buffer_load_dwordx4 v[104:107], v7, s[28:31], s6 offen offset:2048 sc1
    buffer_load_dwordx4 v[108:111], v27, s[28:31], s6 offen offset:2048 sc1
L_olc_6:
    s_bitcmp1_b32 s64, 7
    s_cbranch_scc0 L_olc_7
    buffer_load_dwordx4 v[112:115], v7, s[28:31], s6 offen offset:3072 sc1
    buffer_load_dwordx4 v[116:119], v27, s[28:31], s6 offen offset:3072 sc1
L_olc_7:
L_onp:
    s_cmp_lg_u32 s5, 0
    s_cbranch_scc1 L_om0
    s_bitcmp1_b32 s4, 0
    s_cbranch_scc0 L_opr0
    v_mfma_f32_32x32x16_bf16 v[40:55], a[0:3], v[56:59], 0
    v_mfma_f32_32x32x16_bf16 a[64:79], a[0:3], v[60:63], 0
    v_mfma_f32_32x32x16_bf16 a[80:95], a[4:7], v[56:59], 0
    v_mfma_f32_32x32x16_bf16 a[96:111], a[4:7], v[60:63], 0
    s_mov_b32 s5, 1
L_om0:
    s_cmp_lg_u32 s5, 1
    s_cbranch_scc1 L_om1
    s_bitcmp1_b32 s4, 1
    s_cbranch_scc0 L_opr0
    v_mfma_f32_32x32x16_bf16 v[40:55], a[8:11], v[64:67], v[40:55]
    v_mfma_f32_32x32x16_bf16 a[64:79], a[8:11], v[68:71], a[64:79]
    v_mfma_f32_32x32x16_bf16 a[80:95], a[12:15], v[64:67], a[80:95]
    v_mfma_f32_32x32x16_bf16 a[96:111], a[12:15], v[68:71], a[96:111]
    s_mov_b32 s5, 2
L_om1:
    s_cmp_lg_u32 s5, 2
    s_cbranch_scc1 L_om2
    s_bitcmp1_b32 s4, 2
    s_cbranch_scc0 L_opr0
    v_mfma_f32_32x32x16_bf16 v[40:55], a[16:19], v[72:75], v[40:55]
    v_mfma_f32_32x32x16_bf16 a[64:79], a[16:19], v[76:79], a[64:79]
    v_mfma_f32_32x32x16_bf16 a[80:95], a[20:23], v[72:75], a[80:95]
    v_mfma_f32_32x32x16_bf16 a[96:111], a[20:23], v[76:79], a[96:111]
    s_mov_b32 s5, 3
L_om2:
    s_cmp_lg_u32 s5, 3
    s_cbranch_scc1 L_om3
    s_bitcmp1_b32 s4, 3
    s_cbranch_scc0 L_opr0
    v_mfma_f32_32x32x16_bf16 v[40:55], a[24:27], v[80:83], v[40:55]
    v_mfma_f32_32x32x16_bf16 a[64:79], a[24:27], v[84:87], a[64:79]
    v_mfma_f32_32x32x16_bf16 a[80:95], a[28:31], v[80:83], a[80:95]
    v_mfma_f32_32x32x16_bf16 a[96:111], a[28:31], v[84:87], a[96:111]
    s_mov_b32 s5, 4
L_om3:
    s_cmp_lg_u32 s5, 4
    s_cbranch_scc1 L_om4
    s_bitcmp1_b32 s4, 4
    s_cbranch_scc0 L_opr0
    v_mfma_f32_32x32x16_bf16 v[40:55], a[32:35], v[88:91], v[40:55]
    v_mfma_f32_32x32x16_bf16 a[64:79], a[32:35], v[92:95], a[64:79]
    v_mfma_f32_32x32x16_bf16 a[80:95], a[36:39], v[88:91], a[80:95]
    v_mfma_f32_32x32x16_bf16 a[96:111], a[36:39], v[92:95], a[96:111]
    s_mov_b32 s5, 5
L_om4:
    s_cmp_lg_u32 s5, 5
    s_cbranch_scc1 L_om5
    s_bitcmp1_b32 s4, 5
    s_cbranch_scc0 L_opr0
    v_mfma_f32_32x32x16_bf16 v[40:55], a[40:43], v[96:99], v[40:55]
    v_mfma_f32_32x32x16_bf16 a[64:79], a[40:43], v[100:103], a[64:79]
    v_mfma_f32_32x32x16_bf16 a[80:95], a[44:47], v[96:99], a[80:95]
    v_mfma_f32_32x32x16_bf16 a[96:111], a[44:47], v[100:103], a[96:111]
    s_mov_b32 s5, 6
L_om5:
    s_cmp_lg_u32 s5, 6
    s_cbranch_scc1 L_om6
    s_bitcmp1_b32 s4, 6
    s_cbranch_scc0 L_opr0
    v_mfma_f32_32x32x16_bf16 v[40:55], a[48:51], v[104:107], v[40:55]
    v_mfma_f32_32x32x16_bf16 a[64:79], a[48:51], v[108:111], a[64:79]
    v_mfma_f32_32x32x16_bf16 a[80:95], a[52:55], v[104:107], a[80:95]
    v_mfma_f32_32x32x16_bf16 a[96:111], a[52:55], v[108:111], a[96:111]
    s_mov_b32 s5, 7
L_om6:
    s_cmp_lg_u32 s5, 7
    s_cbranch_scc1 L_om7
    s_bitcmp1_b32 s4, 7
    s_cbranch_scc0 L_opr0
    v_mfma_f32_32x32x16_bf16 v[40:55], a[56:59], v[112:115], v[40:55]
    v_mfma_f32_32x32x16_bf16 a[64:79], a[56:59], v[116:119], a[64:79]
    v_mfma_f32_32x32x16_bf16 a[80:95], a[60:63], v[112:115], a[80:95]
    v_mfma_f32_32x32x16_bf16 a[96:111], a[60:63], v[116:119], a[96:111]
    s_mov_b32 s5, 8
L_om7:
    s_branch L_odone
L_opr0:
    s_cmp_ge_u32 s65, 4
    s_cbranch_scc1 L_of
L_opr:
    s_waitcnt vmcnt(0)
    v_cmp_ne_u32 vcc, -1, v22
    s_sub_u32 s47, s47, 1
    s_lshr_b32 s64, vcc_lo, 8
    s_and_b32 s64, s64, vcc_lo
    s_cmp_lt_i32 s47, 0
    s_cselect_b32 s64, 0xff, s64
    s_and_b32 s64, s64, 0xff
    s_andn2_b32 s64, s64, s4
    s_cbranch_scc1 L_opg
    s_sleep 2
    s_mov_b64 exec, 0xffff
    buffer_load_dword v22, v23, s[28:31], s7 offen offset:1020 sc1
    s_mov_b64 exec, -1
    s_branch L_opr
L_opg:
    s_bitcmp1_b32 s64, 0
    s_cbranch_scc0 L_olb_0
    buffer_load_dwordx4 v[56:59], v7, s[28:31], s7 offen offset:0 sc1
    buffer_load_dwordx4 v[60:63], v27, s[28:31], s7 offen offset:0 sc1
L_olb_0:
    s_bitcmp1_b32 s64, 1
    s_cbranch_scc0 L_olb_1
    buffer_load_dwordx4 v[64:67], v7, s[28:31], s7 offen offset:1024 sc1
    buffer_load_dwordx4 v[68:71], v27, s[28:31], s7 offen offset:1024 sc1
L_olb_1:
    s_bitcmp1_b32 s64, 2
    s_cbranch_scc0 L_olb_2
    buffer_load_dwordx4 v[72:75], v7, s[28:31], s7 offen offset:2048 sc1
    buffer_load_dwordx4 v[76:79], v27, s[28:31], s7 offen offset:2048 sc1
L_olb_2:
    s_bitcmp1_b32 s64, 3
    s_cbranch_scc0 L_olb_3
    buffer_load_dwordx4 v[80:83], v7, s[28:31], s7 offen offset:3072 sc1
    buffer_load_dwordx4 v[84:87], v27, s[28:31], s7 offen offset:3072 sc1
L_olb_3:
    s_bitcmp1_b32 s64, 4
    s_cbranch_scc0 L_olb_4
    buffer_load_dwordx4 v[88:91], v7, s[28:31], s6 offen offset:0 sc1
    buffer_load_dwordx4 v[92:95], v27, s[28:31], s6 offen offset:0 sc1
L_olb_4:
    s_bitcmp1_b32 s64, 5
    s_cbranch_scc0 L_olb_5
    buffer_load_dwordx4 v[96:99], v7, s[28:31], s6 offen offset:1024 sc1
    buffer_load_dwordx4 v[100:103], v27, s[28:31], s6 offen offset:1024 sc1
L_olb_5:
    s_bitcmp1_b32 s64, 6
    s_cbranch_scc0 L_olb_6
    buffer_load_dwordx4 v[104:107], v7, s[28:31], s6 offen offset:2048 sc1
    buffer_load_dwordx4 v[108:111], v27, s[28:31], s6 offen offset:2048 sc1
L_olb_6:
    s_bitcmp1_b32 s64, 7
    s_cbranch_scc0 L_olb_7
    buffer_load_dwordx4 v[112:115], v7, s[28:31], s6 offen offset:3072 sc1
    buffer_load_dwordx4 v[116:119], v27, s[28:31], s6 offen offset:3072 sc1
L_olb_7:
    s_branch L_of
L_chk62:
    ds_read_b32 v20, v0 offset:0
    s_waitcnt lgkmcnt(0)
    v_cmp_gt_u32 vcc, s56, v20
    s_cbranch_vccz L_chk62_x
    s_sub_u32 s47, s47, 1
    s_cmp_lt_i32 s47, 0
    s_cbranch_scc1 L_chk62_x
    s_branch L_chk62
L_attn:
    s_add_u32 m0, s51, 32768
    s_add_u32 s64, s52, 787456
    buffer_load_dwordx4 v6, s[12:15], s64 offen lds
    buffer_load_dwordx4 v7, s[12:15], s64 offen offset:1024 lds
    s_add_u32 s64, s52, 834560
    buffer_load_dwordx4 v6, s[12:15], s64 offen offset:2048 lds
    buffer_load_dwordx4 v7, s[12:15], s64 offen offset:3072 lds
    s_add_u32 m0, s51, 49152
    s_add_u32 s64, s52, 1180672
    buffer_load_dwordx4 v6, s[12:15], s64 offen lds
    buffer_load_dwordx4 v7, s[12:15], s64 offen offset:1024 lds
    s_add_u32 s64, s52, 1227776
    buffer_load_dwordx4 v6, s[12:15], s64 offen offset:2048 lds
    buffer_load_dwordx4 v7, s[12:15], s64 offen offset:3072 lds
    s_mov_b64 exec, 0xffff0000
    buffer_load_dword v143, v26, s[12:15], s7 offen
    s_mov_b64 exec, -1
    s_mov_b64 exec, 0xffffffff
    buffer_load_dword v143, v30, s[16:19], s68 offen
    s_mov_b64 exec, -1
    s_add_u32 m0, s51, 65536
    s_add_u32 s64, s52, 2048
    buffer_load_dwordx4 v6, s[12:15], s64 offen lds
    buffer_load_dwordx4 v7, s[12:15], s64 offen offset:1024 lds
    s_add_u32 s64, s52, 49152
    buffer_load_dwordx4 v6, s[12:15], s64 offen offset:2048 lds
    buffer_load_dwordx4 v7, s[12:15], s64 offen offset:3072 lds
    ds_add_u32 v18, v19
    s_waitcnt lgkmcnt(0)
    s_barrier
    ds_add_u32 v18, v19
    s_waitcnt vmcnt(10)
    ds_add_u32 v18, v19
    s_waitcnt vmcnt(6)
    ds_add_u32 v18, v19
    s_waitcnt vmcnt(0)
    ds_add_u32 v18, v19
    v_mul_u32_u24 v8, 2752, v2
    v_add_u32 v8, v8, v5
    v_add_u32 v9, 20992, v8
    s_mul_i32 s53, s49, 88064
    s_lshl_b32 s43, s59, 7
    s_add_u32 s53, s53, s43
    s_and_b32 s43, s2, 7
    s_lshr_b32 s44, s2, 3
    s_and_b32 s45, s44, 3
    s_lshl_b32 s57, s43, 2
    s_add_u32 s57, s57, s45
    s_lshr_b32 s44, s44, 2
    s_lshl_b32 s44, s44, 1
    s_add_u32 s44, s44, s49
    s_lshr_b32 s4, s40, 1
    s_lshl_b32 s5, s57, 16
    s_lshl_b32 s55, s44, 12
    s_add_u32 s55, s55, s5
    s_lshl_b32 s6, s4, 11
    s_add_u32 s63, s55, s6
    s_xor_b32 s6, s6, 2048
    s_add_u32 s55, s55, s6
    s_lshl_b32 s44, s44, 1
    s_add_u32 s44, s44, s4
    s_lshl_b32 s62, s44, 12
    s_lshl_b32 s43, s57, 7
    s_add_u32 s62, s62, s43
    s_add_u32 s62, s62, 25821184
    s_add_u32 s61, s5, 2097152
    s_lshl_b32 s43, s4, 15
    s_add_u32 s56, s61, s43
    v_mov_b32 v10, v21
    v_lshrrev_b32 v11, 5, v1
    v_lshlrev_b32 v11, 8, v11
    v_and_b32 v27, 15, v1
    v_lshl_add_u32 v11, v27, 4, v11
    v_add_u32 v11, 2097152, v11
    s_mov_b32 s58, 0x0000ffff
    s_mov_b32 s59, 0x0000ffff
    s_mov_b32 s50, 1
    s_mov_b32 s54, 0xc2c80000
    v_mov_b32 v12, 0xdddddddd
    v_and_b32 v24, 27, v1
    v_cmp_eq_u32 vcc, 16, v24
    v_mov_b32 v24, 0x3f803f80
    s_lshr_b32 s65, s57, 1
    v_cndmask_b32 v24, 0, v24, vcc
    s_lshl_b32 s65, s65, 13
    s_add_u32 s65, s65, 25165824
    v_lshlrev_b32 v28, 7, v1
    s_lshr_b32 s66, s63, 3
    s_add_u32 s66, s66, 27262976
    s_lshr_b32 s67, s55, 3
    s_add_u32 s67, s67, 27262976
    v_and_b32 v27, 31, v1
    v_lshlrev_b32 v27, 2, v27
    ds_read_b32 v20, v0 offset:0
    s_waitcnt lgkmcnt(0)
    v_cmp_gt_u32 vcc, 1, v20
    s_cbranch_vccnz L_chk63
L_chk63_x:
    s_add_u32 m0, s51, 81920
    s_add_u32 s64, s52, 395264
    buffer_load_dwordx4 v6, s[12:15], s64 offen lds
    buffer_load_dwordx4 v7, s[12:15], s64 offen offset:1024 lds
    s_add_u32 s64, s52, 442368
    buffer_load_dwordx4 v6, s[12:15], s64 offen offset:2048 lds
    buffer_load_dwordx4 v7, s[12:15], s64 offen offset:3072 lds
    s_add_u32 m0, s51, 98304
    s_add_u32 s64, s52, 788480
    buffer_load_dwordx4 v6, s[12:15], s64 offen lds
    buffer_load_dwordx4 v7, s[12:15], s64 offen offset:1024 lds
    s_add_u32 s64, s52, 835584
    buffer_load_dwordx4 v6, s[12:15], s64 offen offset:2048 lds
    buffer_load_dwordx4 v7, s[12:15], s64 offen offset:3072 lds
    s_waitcnt vmcnt(4)
    ds_add_u32 v18, v19
    s_add_u32 m0, s51, 114688
    s_add_u32 s64, s52, 1181696
    buffer_load_dwordx4 v6, s[12:15], s64 offen lds
    buffer_load_dwordx4 v7, s[12:15], s64 offen offset:1024 lds
    s_add_u32 s64, s52, 1228800
    buffer_load_dwordx4 v6, s[12:15], s64 offen offset:2048 lds
    buffer_load_dwordx4 v7, s[12:15], s64 offen offset:3072 lds
    s_waitcnt vmcnt(4)
    ds_add_u32 v18, v19
    s_add_u32 m0, s51, 0
    s_add_u32 s64, s52, 0
    buffer_load_dwordx4 v6, s[12:15], s64 offen lds
    buffer_load_dwordx4 v7, s[12:15], s64 offen offset:1024 lds
    s_add_u32 s64, s52, 47104
    buffer_load_dwordx4 v6, s[12:15], s64 offen offset:2048 lds
    buffer_load_dwordx4 v7, s[12:15], s64 offen offset:3072 lds
    v_accvgpr_write_b32 a84, v24
    v_accvgpr_write_b32 a85, v24
    v_accvgpr_write_b32 a86, v24
    v_accvgpr_write_b32 a87, v24
    v_accvgpr_write_b32 a88, v24
    v_accvgpr_write_b32 a89, v24
    v_accvgpr_write_b32 a90, v24
    v_accvgpr_write_b32 a91, v24
    v_accvgpr_write_b32 a96, v24
    v_accvgpr_write_b32 a97, v24
    v_accvgpr_write_b32 a98, v24
    v_accvgpr_write_b32 a99, v24
    v_accvgpr_write_b32 a100, v24
    v_accvgpr_write_b32 a101, v24
    v_accvgpr_write_b32 a102, v24
    v_accvgpr_write_b32 a103, v24
    v_accvgpr_write_b32 a0, 0
    v_accvgpr_write_b32 a1, 0
    v_accvgpr_write_b32 a2, 0
    v_accvgpr_write_b32 a3, 0
    s_waitcnt vmcnt(4)
    ds_add_u32 v18, v19
    ds_read_b32 v20, v0 offset:0
    s_waitcnt lgkmcnt(0)
    v_cmp_gt_u32 vcc, 2, v20
    s_cbranch_vccnz L_chk64
L_chk64_x:
    s_add_u32 m0, s51, 16384
    s_add_u32 s64, s52, 393216
    buffer_load_dwordx4 v6, s[12:15], s64 offen lds
    buffer_load_dwordx4 v7, s[12:15], s64 offen offset:1024 lds
    s_add_u32 s64, s52, 440320
    buffer_load_dwordx4 v6, s[12:15], s64 offen offset:2048 lds
    buffer_load_dwordx4 v7, s[12:15], s64 offen offset:3072 lds
    v_accvgpr_write_b32 a4, 0
    v_accvgpr_write_b32 a5, 0
    v_accvgpr_write_b32 a6, 0
    v_accvgpr_write_b32 a7, 0
    v_accvgpr_write_b32 a8, 0
    v_accvgpr_write_b32 a9, 0
    v_accvgpr_write_b32 a10, 0
    v_accvgpr_write_b32 a11, 0
    v_accvgpr_write_b32 a12, 0
    v_accvgpr_write_b32 a13, 0
    v_accvgpr_write_b32 a14, 0
    v_accvgpr_write_b32 a15, 0
    v_accvgpr_write_b32 a16, 0
    v_accvgpr_write_b32 a17, 0
    v_accvgpr_write_b32 a18, 0
    v_accvgpr_write_b32 a19, 0
    v_accvgpr_write_b32 a20, 0
    v_accvgpr_write_b32 a21, 0
    v_accvgpr_write_b32 a22, 0
    v_accvgpr_write_b32 a23, 0
    s_waitcnt vmcnt(4)
    ds_add_u32 v18, v19
    ds_read_b32 v20, v0 offset:0
    s_waitcnt lgkmcnt(0)
    v_cmp_gt_u32 vcc, 3, v20
    s_cbranch_vccnz L_chk65
L_chk65_x:
    s_add_u32 m0, s51, 32768
    s_add_u32 s64, s52, 786432
    buffer_load_dwordx4 v6, s[12:15], s64 offen lds
    buffer_load_dwordx4 v7, s[12:15], s64 offen offset:1024 lds
    s_add_u32 s64, s52, 833536
    buffer_load_dwordx4 v6, s[12:15], s64 offen offset:2048 lds
    buffer_load_dwordx4 v7, s[12:15], s64 offen offset:3072 lds
    v_accvgpr_write_b32 a24, 0
    v_accvgpr_write_b32 a25, 0
    v_accvgpr_write_b32 a26, 0
    v_accvgpr_write_b32 a27, 0
    v_accvgpr_write_b32 a28, 0
    v_accvgpr_write_b32 a29, 0
    v_accvgpr_write_b32 a30, 0
    v_accvgpr_write_b32 a31, 0
    v_accvgpr_write_b32 a32, 0
    v_accvgpr_write_b32 a33, 0
    v_accvgpr_write_b32 a34, 0
    v_accvgpr_write_b32 a35, 0
    v_accvgpr_write_b32 a36, 0
    v_accvgpr_write_b32 a37, 0
    v_accvgpr_write_b32 a38, 0
    v_accvgpr_write_b32 a39, 0
    v_accvgpr_write_b32 a40, 0
    v_accvgpr_write_b32 a41, 0
    v_accvgpr_write_b32 a42, 0
    v_accvgpr_write_b32 a43, 0
    s_waitcnt vmcnt(4)
    ds_add_u32 v18, v19
    ds_read_b32 v20, v0 offset:0
    s_waitcnt lgkmcnt(0)
    v_cmp_gt_u32 vcc, 4, v20
    s_cbranch_vccnz L_chk66
L_chk66_x:
    s_add_u32 m0, s51, 49152
    s_add_u32 s64, s52, 1179648
    buffer_load_dwordx4 v6, s[12:15], s64 offen lds
    buffer_load_dwordx4 v7, s[12:15], s64 offen offset:1024 lds
    s_add_u32 s64, s52, 1226752
    buffer_load_dwordx4 v6, s[12:15], s64 offen offset:2048 lds
    buffer_load_dwordx4 v7, s[12:15], s64 offen offset:3072 lds
    v_accvgpr_write_b32 a44, 0
    v_accvgpr_write_b32 a45, 0
    v_accvgpr_write_b32 a46, 0
    v_accvgpr_write_b32 a47, 0
    v_accvgpr_write_b32 a48, 0
    v_accvgpr_write_b32 a49, 0
    v_accvgpr_write_b32 a50, 0
    v_accvgpr_write_b32 a51, 0
    v_accvgpr_write_b32 a52, 0
    v_accvgpr_write_b32 a53, 0
    v_accvgpr_write_b32 a54, 0
    v_accvgpr_write_b32 a55, 0
    v_accvgpr_write_b32 a56, 0
    v_accvgpr_write_b32 a57, 0
    v_accvgpr_write_b32 a58, 0
    v_accvgpr_write_b32 a59, 0
    v_accvgpr_write_b32 a60, 0
    v_accvgpr_write_b32 a61, 0
    v_accvgpr_write_b32 a62, 0
    v_accvgpr_write_b32 a63, 0
    v_mov_b32 v3, 0
    buffer_load_dword v15, v3, s[36:39], 0 offen sc1
    s_waitcnt vmcnt(5)
    ds_add_u32 v18, v19
    ds_read_b32 v20, v0 offset:0
    s_waitcnt lgkmcnt(0)
    v_cmp_gt_u32 vcc, 5, v20
    s_cbranch_vccnz L_chk67
L_chk67_x:
    s_waitcnt vmcnt(1)
    ds_add_u32 v18, v19
    s_add_u32 m0, s51, 65536
    s_add_u32 s64, s53, 0
    buffer_load_dwordx4 v8, s[16:19], s64 offen lds
    buffer_load_dwordx4 v9, s[16:19], s64 offen offset:1024 lds
    s_add_u32 s64, s53, 41984
    buffer_load_dwordx4 v8, s[16:19], s64 offen offset:2048 lds
    buffer_load_dwordx4 v9, s[16:19], s64 offen offset:3072 lds
    s_waitcnt vmcnt(0)
    ds_add_u32 v18, v19
    s_waitcnt vmcnt(0)
    v_readfirstlane_b32 s46, v15
    s_cmp_lg_u32 s46, 0
    s_cbranch_scc1 L_atag_x
    v_mov_b32 v3, 0
L_atag:
    buffer_load_dword v15, v3, s[36:39], 0 offen sc1
    s_waitcnt vmcnt(0)
    v_readfirstlane_b32 s46, v15
    s_sub_u32 s47, s47, 1
    s_cmp_lt_i32 s47, 0
    s_cbranch_scc1 L_atag_x
    s_cmp_eq_u32 s46, 0
    s_cbranch_scc1 L_atag
L_atag_x:
    s_mov_b32 s62, 0
    s_setprio 2
    s_cmp_lg_u32 s40, 0
    s_cbranch_scc1 L_aw
L_ag2:
    ds_read_b32 v6, v0 offset:0
    s_waitcnt lgkmcnt(0)
    v_cmp_gt_u32 vcc, 12, v6
    s_cbranch_vccz L_ag2_x
    s_sub_u32 s47, s47, 1
    s_cmp_lt_i32 s47, 0
    s_cbranch_scc1 L_ag2_x
    s_sleep 2
    s_branch L_ag2
L_ag2_x:
L_qf:
    s_sleep 8
    s_mov_b64 exec, -1
    buffer_load_dword v15, v28, s[28:31], s65 offen sc1
    s_waitcnt vmcnt(0)
    v_cmp_ne_u32 vcc, s46, v15
    s_mov_b64 exec, -1
    s_cbranch_vccz L_qf_x
    s_sub_u32 s47, s47, 1
    s_cmp_lt_i32 s47, 0
    s_cbranch_scc1 L_qf_x
    s_branch L_qf
L_qf_x:
    ds_write_b32 v29, v19
    s_branch L_aw_x
L_aw:
L_ag3:
    ds_read_b32 v6, v29 offset:0
    s_waitcnt lgkmcnt(0)
    v_cmp_eq_u32 vcc, 0, v6
    s_cbranch_vccz L_ag3_x
    s_sub_u32 s47, s47, 1
    s_cmp_lt_i32 s47, 0
    s_cbranch_scc1 L_ag3_x
    s_sleep 1
    s_branch L_ag3
L_ag3_x:
L_aw_x:
    buffer_load_dwordx4 v[80:83], v10, s[28:31], s63 offen offset:0 sc1
    buffer_load_dwordx4 v[84:87], v10, s[28:31], s63 offen offset:1024 sc1
    buffer_load_dwordx4 v[88:91], v10, s[28:31], s55 offen offset:0 sc1
    buffer_load_dwordx4 v[92:95], v10, s[28:31], s55 offen offset:1024 sc1
    buffer_load_dword v6, v27, s[28:31], s66 offen offset:0 sc1
    buffer_load_dword v7, v27, s[28:31], s66 offen offset:128 sc1
    buffer_load_dword v8, v27, s[28:31], s67 offen offset:0 sc1
    buffer_load_dword v9, v27, s[28:31], s67 offen offset:128 sc1
    s_and_b32 s4, s40, 1
    s_lshl_b32 s4, s4, 21
    s_add_u32 s4, s4, s56
    s_mul_i32 s5, s40, 10560
    s_add_u32 s6, s4, 0
    s_add_u32 m0, s5, 0
    s_nop 0
    buffer_load_dwordx4 v10, s[28:31], s6 offen offset:0 sc1 lds
    s_add_u32 m0, s5, 32
    s_nop 0
    buffer_load_dwordx4 v10, s[28:31], s6 offen offset:1024 sc1 lds
    s_add_u32 m0, s5, 64
    s_nop 0
    buffer_load_dwordx4 v10, s[28:31], s6 offen offset:2048 sc1 lds
    s_add_u32 m0, s5, 96
    s_nop 0
    buffer_load_dwordx4 v10, s[28:31], s6 offen offset:3072 sc1 lds
    s_add_u32 s6, s4, 4096
    s_add_u32 m0, s5, 4224
    s_nop 0
    buffer_load_dwordx4 v10, s[28:31], s6 offen offset:0 sc1 lds
    v_subrev_u32 v2, 1024, v18
    v_mov_b32 v3, 1
    v_lshrrev_b32 v32, 1, v1
    v_mul_u32_u24 v32, 1056, v32
    v_and_b32 v33, 1, v1
    v_lshl_add_u32 v32, v33, 4, v32
    v_add_u32 v32, s5, v32
    v_cmp_eq_u32 vcc, 0, v33
    v_mov_b32 v36, 0x3f803f80
    s_lshr_b32 s4, s40, 1
    v_cndmask_b32 v36, 0, v36, vcc
    s_mul_i32 s4, s4, 21120
    v_mov_b32 v37, v36
    v_mov_b32 v38, v36
    v_mov_b32 v39, v36
    s_mov_b64 exec, 0xfffff
    ds_write_b128 v32, v[36:39] offset:1024
    s_mov_b64 exec, -1
    v_add_u32 v4, s4, v10
    s_sub_u32 s6, s4, 2086592
    v_add_u32 v5, s6, v11
    v_add_u32 v15, 512, v5
    s_add_u32 s4, s4, 11584
    v_cmp_eq_u32 vcc, 0, v24
    v_mov_b32 v32, s4
    v_add_u32 v33, 16, v32
    v_cndmask_b32 v32, v32, v33, vcc
    v_cndmask_b32 v5, v32, v5, s[58:59]
    v_cndmask_b32 v15, v32, v15, s[58:59]
    s_waitcnt vmcnt(5)
    v_max3_u32 v96, v80, v81, v95
    v_max3_u32 v96, v82, v83, v96
    v_max3_u32 v96, v84, v85, v96
    v_max3_u32 v96, v86, v87, v96
    v_max3_u32 v96, v88, v89, v96
    v_max3_u32 v96, v90, v91, v96
    v_max3_u32 v96, v92, v93, v96
    v_max3_u32 v96, v94, v95, v96
    v_max3_u32 v96, v96, v6, v7
    v_max3_u32 v96, v96, v8, v9
    v_cmp_eq_u32 vcc, -1, v96
    s_cbranch_vccnz L_qre
L_qre_x:
    v_mov_b32 v112, 5
    s_waitcnt vmcnt(0)
    ds_add_u32 v2, v112 offset:512
    ds_add_u32 v2, v3 offset:1024
    v_accvgpr_write_b32 a64, v80
    v_accvgpr_write_b32 a65, v81
    v_accvgpr_write_b32 a66, v82
    v_accvgpr_write_b32 a67, v83
    v_accvgpr_write_b32 a68, v84
    v_accvgpr_write_b32 a69, v85
    v_accvgpr_write_b32 a70, v86
    v_accvgpr_write_b32 a71, v87
    v_accvgpr_write_b32 a72, v88
    v_accvgpr_write_b32 a73, v89
    v_accvgpr_write_b32 a74, v90
    v_accvgpr_write_b32 a75, v91
    v_accvgpr_write_b32 a76, v92
    v_accvgpr_write_b32 a77, v93
    v_accvgpr_write_b32 a78, v94
    v_accvgpr_write_b32 a79, v95
L_akv:
    ds_read_b32 v88, v0 offset:512
    s_waitcnt lgkmcnt(0)
    v_cmp_gt_u32 vcc, 5, v88
    s_cbranch_vccz L_akv_x
    s_sub_u32 s47, s47, 1
    s_cmp_lt_i32 s47, 0
    s_cbranch_scc1 L_akv_x
    s_branch L_akv
L_akv_x:
    ds_read_b128 a[80:83], v4 offset:0
    ds_read_b128 a[84:87], v5 offset:0
    ds_read_b128 a[88:91], v15 offset:0
    ds_add_u32 v2, v3 offset:1024
    v_pk_mov_b32 v[16:17], v[6:7], v[6:7] op_sel:[0,0]
    v_pk_mov_b32 v[18:19], v[6:7], v[6:7] op_sel:[0,0]
    v_pk_mov_b32 v[20:21], v[6:7], v[6:7] op_sel:[0,0]
    v_pk_mov_b32 v[22:23], v[6:7], v[6:7] op_sel:[0,0]
    v_pk_mov_b32 v[24:25], v[6:7], v[6:7] op_sel:[0,0]
    v_pk_mov_b32 v[26:27], v[6:7], v[6:7] op_sel:[0,0]
    v_pk_mov_b32 v[28:29], v[6:7], v[6:7] op_sel:[0,0]
    v_pk_mov_b32 v[30:31], v[6:7], v[6:7] op_sel:[0,0]
    s_nop 0
    s_waitcnt lgkmcnt(0)
    v_mfma_f32_32x32x16_bf16 v[80:95], a[80:83], a[64:67], v[16:31]
    v_pk_mov_b32 v[32:33], v[6:7], v[6:7] op_sel:[1,1]
    v_pk_mov_b32 v[34:35], v[6:7], v[6:7] op_sel:[1,1]
    v_pk_mov_b32 v[36:37], v[6:7], v[6:7] op_sel:[1,1]
    v_pk_mov_b32 v[38:39], v[6:7], v[6:7] op_sel:[1,1]
    v_pk_mov_b32 v[40:41], v[6:7], v[6:7] op_sel:[1,1]
    v_pk_mov_b32 v[42:43], v[6:7], v[6:7] op_sel:[1,1]
    v_pk_mov_b32 v[44:45], v[6:7], v[6:7] op_sel:[1,1]
    v_pk_mov_b32 v[46:47], v[6:7], v[6:7] op_sel:[1,1]
    v_pk_mov_b32 v[48:49], v[8:9], v[8:9] op_sel:[0,0]
    v_pk_mov_b32 v[50:51], v[8:9], v[8:9] op_sel:[0,0]
    v_pk_mov_b32 v[52:53], v[8:9], v[8:9] op_sel:[0,0]
    v_pk_mov_b32 v[54:55], v[8:9], v[8:9] op_sel:[0,0]
    v_pk_mov_b32 v[56:57], v[8:9], v[8:9] op_sel:[0,0]
    v_pk_mov_b32 v[58:59], v[8:9], v[8:9] op_sel:[0,0]
    v_pk_mov_b32 v[60:61], v[8:9], v[8:9] op_sel:[0,0]
    v_pk_mov_b32 v[62:63], v[8:9], v[8:9] op_sel:[0,0]
    v_pk_mov_b32 v[64:65], v[8:9], v[8:9] op_sel:[1,1]
    v_pk_mov_b32 v[66:67], v[8:9], v[8:9] op_sel:[1,1]
    v_pk_mov_b32 v[68:69], v[8:9], v[8:9] op_sel:[1,1]
    v_pk_mov_b32 v[70:71], v[8:9], v[8:9] op_sel:[1,1]
    v_pk_mov_b32 v[72:73], v[8:9], v[8:9] op_sel:[1,1]
    v_pk_mov_b32 v[74:75], v[8:9], v[8:9] op_sel:[1,1]
    v_pk_mov_b32 v[76:77], v[8:9], v[8:9] op_sel:[1,1]
    v_pk_mov_b32 v[78:79], v[8:9], v[8:9] op_sel:[1,1]
    v_pk_mov_b32 v[136:137], 0, 0
    v_pk_mov_b32 v[138:139], 0, 0
    v_pk_mov_b32 v[140:141], 0, 0
    v_pk_mov_b32 v[142:143], 0, 0
    v_mov_b32 v6, 5
    s_mov_b32 s51, 3
    s_mov_b32 s49, 3
    s_lshr_b32 s4, s40, 1
    s_mul_i32 s4, s4, -42240
    s_add_u32 s4, s4, 21120
    v_add_u32 v7, s4, v4
    v_add_u32 v8, s4, v5
    v_add_u32 v9, s4, v15
.p2align 6
L_aloop:
    v_mfma_f32_32x32x16_bf16 v[96:111], a[80:83], a[68:71], v[32:47]
    v_exp_f32 v80, v80
    v_exp_f32 v81, v81
    v_exp_f32 v82, v82
    v_cmp_gt_u32 vcc, s49, v6
    s_cbranch_vccnz L_akc68
    L_akc68_x:
    v_exp_f32 v83, v83
    v_exp_f32 v84, v84
    v_smfmac_f32_32x32x32_bf16 a[48:63], a[100:103], v[136:143], v12
    v_exp_f32 v85, v85
    v_exp_f32 v86, v86
    v_exp_f32 v87, v87
    ds_read_b128 a[92:95], v4 offset:1056
    v_exp_f32 v88, v88
    v_exp_f32 v89, v89
    v_exp_f32 v90, v90
    v_smfmac_f32_32x32x32_bf16 a[0:15], a[84:87], v[80:87], v12
    v_exp_f32 v91, v91
    v_exp_f32 v92, v92
    v_exp_f32 v93, v93
    ds_read_b128 a[96:99], v5 offset:1056
    v_exp_f32 v94, v94
    v_exp_f32 v95, v95
    v_mfma_f32_32x32x16_bf16 v[112:127], a[80:83], a[72:75], v[48:63]
    v_exp_f32 v96, v96
    v_exp_f32 v97, v97
    v_exp_f32 v98, v98
    ds_read_b128 a[100:103], v15 offset:1056
    v_exp_f32 v99, v99
    v_exp_f32 v100, v100
    v_smfmac_f32_32x32x32_bf16 a[0:15], a[88:91], v[88:95], v12
    v_exp_f32 v101, v101
    v_exp_f32 v102, v102
    v_exp_f32 v103, v103
    ds_add_u32 v2, v3 offset:1024
    v_exp_f32 v104, v104
    v_exp_f32 v105, v105
    v_exp_f32 v106, v106
    v_smfmac_f32_32x32x32_bf16 a[16:31], a[84:87], v[96:103], v12
    v_exp_f32 v107, v107
    v_exp_f32 v108, v108
    v_exp_f32 v109, v109
    v_exp_f32 v110, v110
    v_exp_f32 v111, v111
    v_mfma_f32_32x32x16_bf16 v[128:143], a[80:83], a[76:79], v[64:79]
    v_exp_f32 v112, v112
    v_exp_f32 v113, v113
    v_exp_f32 v114, v114
    v_exp_f32 v115, v115
    v_exp_f32 v116, v116
    v_smfmac_f32_32x32x32_bf16 a[16:31], a[88:91], v[104:111], v12
    v_exp_f32 v117, v117
    v_exp_f32 v118, v118
    v_exp_f32 v119, v119
    v_exp_f32 v120, v120
    v_exp_f32 v121, v121
    v_exp_f32 v122, v122
    v_smfmac_f32_32x32x32_bf16 a[32:47], a[84:87], v[112:119], v12
    v_exp_f32 v123, v123
    v_exp_f32 v124, v124
    v_exp_f32 v125, v125
    s_waitcnt lgkmcnt(0)
    v_exp_f32 v126, v126
    v_exp_f32 v127, v127
    v_mfma_f32_32x32x16_bf16 v[80:95], a[92:95], a[64:67], v[16:31]
    v_exp_f32 v128, v128
    v_exp_f32 v129, v129
    v_exp_f32 v130, v130
    v_exp_f32 v131, v131
    v_exp_f32 v132, v132
    v_smfmac_f32_32x32x32_bf16 a[32:47], a[88:91], v[120:127], v12
    v_exp_f32 v133, v133
    v_exp_f32 v134, v134
    v_exp_f32 v135, v135
    v_exp_f32 v136, v136
    v_exp_f32 v137, v137
    v_exp_f32 v138, v138
    v_smfmac_f32_32x32x32_bf16 a[48:63], a[84:87], v[128:135], v12
    v_exp_f32 v139, v139
    v_exp_f32 v140, v140
    v_exp_f32 v141, v141
    v_exp_f32 v142, v142
    v_exp_f32 v143, v143
    v_mfma_f32_32x32x16_bf16 v[96:111], a[92:95], a[68:71], v[32:47]
    v_exp_f32 v80, v80
    v_exp_f32 v81, v81
    v_exp_f32 v82, v82
    ds_read_b128 a[80:83], v4 offset:2112
    v_exp_f32 v83, v83
    v_exp_f32 v84, v84
    v_smfmac_f32_32x32x32_bf16 a[48:63], a[88:91], v[136:143], v12
    v_exp_f32 v85, v85
    v_exp_f32 v86, v86
    v_exp_f32 v87, v87
    ds_read_b128 a[84:87], v5 offset:2112
    v_exp_f32 v88, v88
    v_exp_f32 v89, v89
    v_exp_f32 v90, v90
    v_smfmac_f32_32x32x32_bf16 a[0:15], a[96:99], v[80:87], v12
    v_exp_f32 v91, v91
    v_exp_f32 v92, v92
    v_exp_f32 v93, v93
    ds_read_b128 a[88:91], v15 offset:2112
    v_exp_f32 v94, v94
    v_exp_f32 v95, v95
    v_mfma_f32_32x32x16_bf16 v[112:127], a[92:95], a[72:75], v[48:63]
    v_exp_f32 v96, v96
    v_exp_f32 v97, v97
    v_exp_f32 v98, v98
    ds_read_b32 v6, v0 offset:512
    v_exp_f32 v99, v99
    v_exp_f32 v100, v100
    v_smfmac_f32_32x32x32_bf16 a[0:15], a[100:103], v[88:95], v12
    v_exp_f32 v101, v101
    v_exp_f32 v102, v102
    v_exp_f32 v103, v103
    s_add_u32 s49, s49, 2
    v_exp_f32 v104, v104
    v_exp_f32 v105, v105
    v_exp_f32 v106, v106
    v_smfmac_f32_32x32x32_bf16 a[16:31], a[96:99], v[96:103], v12
    v_exp_f32 v107, v107
    v_exp_f32 v108, v108
    v_exp_f32 v109, v109
    v_exp_f32 v110, v110
    v_exp_f32 v111, v111
    v_mfma_f32_32x32x16_bf16 v[128:143], a[92:95], a[76:79], v[64:79]
    v_exp_f32 v112, v112
    v_exp_f32 v113, v113
    v_exp_f32 v114, v114
    v_exp_f32 v115, v115
    v_exp_f32 v116, v116
    v_smfmac_f32_32x32x32_bf16 a[16:31], a[100:103], v[104:111], v12
    v_exp_f32 v117, v117
    v_exp_f32 v118, v118
    v_exp_f32 v119, v119
    v_exp_f32 v120, v120
    v_exp_f32 v121, v121
    v_exp_f32 v122, v122
    v_smfmac_f32_32x32x32_bf16 a[32:47], a[96:99], v[112:119], v12
    v_exp_f32 v123, v123
    v_exp_f32 v124, v124
    v_exp_f32 v125, v125
    s_waitcnt lgkmcnt(0)
    v_exp_f32 v126, v126
    v_exp_f32 v127, v127
    v_mfma_f32_32x32x16_bf16 v[80:95], a[80:83], a[64:67], v[16:31]
    v_exp_f32 v128, v128
    v_exp_f32 v129, v129
    v_exp_f32 v130, v130
    v_exp_f32 v131, v131
    v_exp_f32 v132, v132
    v_smfmac_f32_32x32x32_bf16 a[32:47], a[100:103], v[120:127], v12
    v_exp_f32 v133, v133
    v_exp_f32 v134, v134
    v_exp_f32 v135, v135
    v_exp_f32 v136, v136
    v_exp_f32 v137, v137
    v_exp_f32 v138, v138
    v_smfmac_f32_32x32x32_bf16 a[48:63], a[96:99], v[128:135], v12
    v_exp_f32 v139, v139
    v_exp_f32 v140, v140
    v_exp_f32 v141, v141
    v_exp_f32 v142, v142
    v_exp_f32 v143, v143
    v_mfma_f32_32x32x16_bf16 v[96:111], a[80:83], a[68:71], v[32:47]
    v_exp_f32 v80, v80
    v_exp_f32 v81, v81
    v_exp_f32 v82, v82
    v_cmp_gt_u32 vcc, s49, v6
    s_cbranch_vccnz L_akc69
    L_akc69_x:
    v_exp_f32 v83, v83
    v_exp_f32 v84, v84
    v_smfmac_f32_32x32x32_bf16 a[48:63], a[100:103], v[136:143], v12
    v_exp_f32 v85, v85
    v_exp_f32 v86, v86
    v_exp_f32 v87, v87
    ds_read_b128 a[92:95], v4 offset:3168
    v_exp_f32 v88, v88
    v_exp_f32 v89, v89
    v_exp_f32 v90, v90
    v_smfmac_f32_32x32x32_bf16 a[0:15], a[84:87], v[80:87], v12
    v_exp_f32 v91, v91
    v_exp_f32 v92, v92
    v_exp_f32 v93, v93
    ds_read_b128 a[96:99], v5 offset:3168
    v_exp_f32 v94, v94
    v_exp_f32 v95, v95
    v_mfma_f32_32x32x16_bf16 v[112:127], a[80:83], a[72:75], v[48:63]
    v_exp_f32 v96, v96
    v_exp_f32 v97, v97
    v_exp_f32 v98, v98
    ds_read_b128 a[100:103], v15 offset:3168
    v_exp_f32 v99, v99
    v_exp_f32 v100, v100
    v_smfmac_f32_32x32x32_bf16 a[0:15], a[88:91], v[88:95], v12
    v_exp_f32 v101, v101
    v_exp_f32 v102, v102
    v_exp_f32 v103, v103
    ds_add_u32 v2, v3 offset:1024
    v_exp_f32 v104, v104
    v_exp_f32 v105, v105
    v_exp_f32 v106, v106
    v_smfmac_f32_32x32x32_bf16 a[16:31], a[84:87], v[96:103], v12
    v_exp_f32 v107, v107
    v_exp_f32 v108, v108
    v_exp_f32 v109, v109
    v_exp_f32 v110, v110
    v_exp_f32 v111, v111
    v_mfma_f32_32x32x16_bf16 v[128:143], a[80:83], a[76:79], v[64:79]
    v_exp_f32 v112, v112
    v_exp_f32 v113, v113
    v_exp_f32 v114, v114
    v_exp_f32 v115, v115
    v_exp_f32 v116, v116
    v_smfmac_f32_32x32x32_bf16 a[16:31], a[88:91], v[104:111], v12
    v_exp_f32 v117, v117
    v_exp_f32 v118, v118
    v_exp_f32 v119, v119
    v_exp_f32 v120, v120
    v_exp_f32 v121, v121
    v_exp_f32 v122, v122
    v_smfmac_f32_32x32x32_bf16 a[32:47], a[84:87], v[112:119], v12
    v_exp_f32 v123, v123
    v_exp_f32 v124, v124
    v_exp_f32 v125, v125
    s_waitcnt lgkmcnt(0)
    v_exp_f32 v126, v126
    v_exp_f32 v127, v127
    v_mfma_f32_32x32x16_bf16 v[80:95], a[92:95], a[64:67], v[16:31]
    v_exp_f32 v128, v128
    v_exp_f32 v129, v129
    v_exp_f32 v130, v130
    v_exp_f32 v131, v131
    v_exp_f32 v132, v132
    v_smfmac_f32_32x32x32_bf16 a[32:47], a[88:91], v[120:127], v12
    v_exp_f32 v133, v133
    v_exp_f32 v134, v134
    v_exp_f32 v135, v135
    v_exp_f32 v136, v136
    v_exp_f32 v137, v137
    v_exp_f32 v138, v138
    v_smfmac_f32_32x32x32_bf16 a[48:63], a[84:87], v[128:135], v12
    v_exp_f32 v139, v139
    v_exp_f32 v140, v140
    v_exp_f32 v141, v141
    v_exp_f32 v142, v142
    v_exp_f32 v143, v143
    v_mfma_f32_32x32x16_bf16 v[96:111], a[92:95], a[68:71], v[32:47]
    v_exp_f32 v80, v80
    v_exp_f32 v81, v81
    v_exp_f32 v82, v82
    ds_read_b128 a[80:83], v4 offset:4224
    v_exp_f32 v83, v83
    v_exp_f32 v84, v84
    v_smfmac_f32_32x32x32_bf16 a[48:63], a[88:91], v[136:143], v12
    v_exp_f32 v85, v85
    v_exp_f32 v86, v86
    v_exp_f32 v87, v87
    ds_read_b128 a[84:87], v5 offset:4224
    v_exp_f32 v88, v88
    v_exp_f32 v89, v89
    v_exp_f32 v90, v90
    v_smfmac_f32_32x32x32_bf16 a[0:15], a[96:99], v[80:87], v12
    v_exp_f32 v91, v91
    v_exp_f32 v92, v92
    v_exp_f32 v93, v93
    ds_read_b128 a[88:91], v15 offset:4224
    v_exp_f32 v94, v94
    v_exp_f32 v95, v95
    v_mfma_f32_32x32x16_bf16 v[112:127], a[92:95], a[72:75], v[48:63]
    v_exp_f32 v96, v96
    v_exp_f32 v97, v97
    v_exp_f32 v98, v98
    ds_read_b32 v6, v0 offset:512
    v_exp_f32 v99, v99
    v_exp_f32 v100, v100
    v_smfmac_f32_32x32x32_bf16 a[0:15], a[100:103], v[88:95], v12
    v_exp_f32 v101, v101
    v_exp_f32 v102, v102
    v_exp_f32 v103, v103
    s_add_u32 s49, s49, 2
    v_exp_f32 v104, v104
    v_exp_f32 v105, v105
    v_exp_f32 v106, v106
    v_smfmac_f32_32x32x32_bf16 a[16:31], a[96:99], v[96:103], v12
    v_exp_f32 v107, v107
    v_exp_f32 v108, v108
    v_exp_f32 v109, v109
    v_exp_f32 v110, v110
    v_exp_f32 v111, v111
    v_mfma_f32_32x32x16_bf16 v[128:143], a[92:95], a[76:79], v[64:79]
    v_exp_f32 v112, v112
    v_exp_f32 v113, v113
    v_exp_f32 v114, v114
    v_exp_f32 v115, v115
    v_exp_f32 v116, v116
    v_smfmac_f32_32x32x32_bf16 a[16:31], a[100:103], v[104:111], v12
    v_exp_f32 v117, v117
    v_exp_f32 v118, v118
    v_exp_f32 v119, v119
    v_exp_f32 v120, v120
    v_exp_f32 v121, v121
    v_exp_f32 v122, v122
    v_smfmac_f32_32x32x32_bf16 a[32:47], a[96:99], v[112:119], v12
    v_exp_f32 v123, v123
    v_exp_f32 v124, v124
    v_exp_f32 v125, v125
    s_waitcnt lgkmcnt(0)
    v_exp_f32 v126, v126
    v_exp_f32 v127, v127
    v_mfma_f32_32x32x16_bf16 v[80:95], a[80:83], a[64:67], v[16:31]
    v_exp_f32 v128, v128
    v_exp_f32 v129, v129
    v_exp_f32 v130, v130
    v_exp_f32 v131, v131
    v_exp_f32 v132, v132
    v_smfmac_f32_32x32x32_bf16 a[32:47], a[100:103], v[120:127], v12
    v_exp_f32 v133, v133
    v_exp_f32 v134, v134
    v_exp_f32 v135, v135
    v_exp_f32 v136, v136
    v_exp_f32 v137, v137
    v_exp_f32 v138, v138
    v_smfmac_f32_32x32x32_bf16 a[48:63], a[96:99], v[128:135], v12
    v_exp_f32 v139, v139
    v_exp_f32 v140, v140
    v_exp_f32 v141, v141
    v_exp_f32 v142, v142
    v_exp_f32 v143, v143
    v_mfma_f32_32x32x16_bf16 v[96:111], a[80:83], a[68:71], v[32:47]
    v_exp_f32 v80, v80
    v_exp_f32 v81, v81
    v_exp_f32 v82, v82
    v_cmp_gt_u32 vcc, s49, v6
    s_cbranch_vccnz L_akc70
    L_akc70_x:
    v_exp_f32 v83, v83
    v_exp_f32 v84, v84
    v_smfmac_f32_32x32x32_bf16 a[48:63], a[100:103], v[136:143], v12
    v_exp_f32 v85, v85
    v_exp_f32 v86, v86
    v_exp_f32 v87, v87
    ds_read_b128 a[92:95], v4 offset:5280
    v_exp_f32 v88, v88
    v_exp_f32 v89, v89
    v_exp_f32 v90, v90
    v_smfmac_f32_32x32x32_bf16 a[0:15], a[84:87], v[80:87], v12
    v_exp_f32 v91, v91
    v_exp_f32 v92, v92
    v_exp_f32 v93, v93
    ds_read_b128 a[96:99], v5 offset:5280
    v_exp_f32 v94, v94
    v_exp_f32 v95, v95
    v_mfma_f32_32x32x16_bf16 v[112:127], a[80:83], a[72:75], v[48:63]
    v_exp_f32 v96, v96
    v_exp_f32 v97, v97
    v_exp_f32 v98, v98
    ds_read_b128 a[100:103], v15 offset:5280
    v_exp_f32 v99, v99
    v_exp_f32 v100, v100
    v_smfmac_f32_32x32x32_bf16 a[0:15], a[88:91], v[88:95], v12
    v_exp_f32 v101, v101
    v_exp_f32 v102, v102
    v_exp_f32 v103, v103
    ds_add_u32 v2, v3 offset:1024
    v_exp_f32 v104, v104
    v_exp_f32 v105, v105
    v_exp_f32 v106, v106
    v_smfmac_f32_32x32x32_bf16 a[16:31], a[84:87], v[96:103], v12
    v_exp_f32 v107, v107
    v_exp_f32 v108, v108
    v_exp_f32 v109, v109
    v_exp_f32 v110, v110
    v_exp_f32 v111, v111
    v_mfma_f32_32x32x16_bf16 v[128:143], a[80:83], a[76:79], v[64:79]
    v_exp_f32 v112, v112
    v_exp_f32 v113, v113
    v_exp_f32 v114, v114
    v_exp_f32 v115, v115
    v_exp_f32 v116, v116
    v_smfmac_f32_32x32x32_bf16 a[16:31], a[88:91], v[104:111], v12
    v_exp_f32 v117, v117
    v_exp_f32 v118, v118
    v_exp_f32 v119, v119
    v_exp_f32 v120, v120
    v_exp_f32 v121, v121
    v_exp_f32 v122, v122
    v_smfmac_f32_32x32x32_bf16 a[32:47], a[84:87], v[112:119], v12
    v_exp_f32 v123, v123
    v_exp_f32 v124, v124
    v_exp_f32 v125, v125
    s_waitcnt lgkmcnt(0)
    v_exp_f32 v126, v126
    v_exp_f32 v127, v127
    v_mfma_f32_32x32x16_bf16 v[80:95], a[92:95], a[64:67], v[16:31]
    v_exp_f32 v128, v128
    v_exp_f32 v129, v129
    v_exp_f32 v130, v130
    v_exp_f32 v131, v131
    v_exp_f32 v132, v132
    v_smfmac_f32_32x32x32_bf16 a[32:47], a[88:91], v[120:127], v12
    v_exp_f32 v133, v133
    v_exp_f32 v134, v134
    v_exp_f32 v135, v135
    v_exp_f32 v136, v136
    v_exp_f32 v137, v137
    v_exp_f32 v138, v138
    v_smfmac_f32_32x32x32_bf16 a[48:63], a[84:87], v[128:135], v12
    v_exp_f32 v139, v139
    v_exp_f32 v140, v140
    v_exp_f32 v141, v141
    v_exp_f32 v142, v142
    v_exp_f32 v143, v143
    v_mfma_f32_32x32x16_bf16 v[96:111], a[92:95], a[68:71], v[32:47]
    v_exp_f32 v80, v80
    v_exp_f32 v81, v81
    v_exp_f32 v82, v82
    ds_read_b128 a[80:83], v4 offset:6336
    v_exp_f32 v83, v83
    v_exp_f32 v84, v84
    v_smfmac_f32_32x32x32_bf16 a[48:63], a[88:91], v[136:143], v12
    v_exp_f32 v85, v85
    v_exp_f32 v86, v86
    v_exp_f32 v87, v87
    ds_read_b128 a[84:87], v5 offset:6336
    v_exp_f32 v88, v88
    v_exp_f32 v89, v89
    v_exp_f32 v90, v90
    v_smfmac_f32_32x32x32_bf16 a[0:15], a[96:99], v[80:87], v12
    v_exp_f32 v91, v91
    v_exp_f32 v92, v92
    v_exp_f32 v93, v93
    ds_read_b128 a[88:91], v15 offset:6336
    v_exp_f32 v94, v94
    v_exp_f32 v95, v95
    v_mfma_f32_32x32x16_bf16 v[112:127], a[92:95], a[72:75], v[48:63]
    v_exp_f32 v96, v96
    v_exp_f32 v97, v97
    v_exp_f32 v98, v98
    ds_read_b32 v6, v0 offset:512
    v_exp_f32 v99, v99
    v_exp_f32 v100, v100
    v_smfmac_f32_32x32x32_bf16 a[0:15], a[100:103], v[88:95], v12
    v_exp_f32 v101, v101
    v_exp_f32 v102, v102
    v_exp_f32 v103, v103
    s_add_u32 s49, s49, 2
    v_exp_f32 v104, v104
    v_exp_f32 v105, v105
    v_exp_f32 v106, v106
    v_smfmac_f32_32x32x32_bf16 a[16:31], a[96:99], v[96:103], v12
    v_exp_f32 v107, v107
    v_exp_f32 v108, v108
    v_exp_f32 v109, v109
    v_exp_f32 v110, v110
    v_exp_f32 v111, v111
    v_mfma_f32_32x32x16_bf16 v[128:143], a[92:95], a[76:79], v[64:79]
    v_exp_f32 v112, v112
    v_exp_f32 v113, v113
    v_exp_f32 v114, v114
    v_exp_f32 v115, v115
    v_exp_f32 v116, v116
    v_smfmac_f32_32x32x32_bf16 a[16:31], a[100:103], v[104:111], v12
    v_exp_f32 v117, v117
    v_exp_f32 v118, v118
    v_exp_f32 v119, v119
    v_exp_f32 v120, v120
    v_exp_f32 v121, v121
    v_exp_f32 v122, v122
    v_smfmac_f32_32x32x32_bf16 a[32:47], a[96:99], v[112:119], v12
    v_exp_f32 v123, v123
    v_exp_f32 v124, v124
    v_exp_f32 v125, v125
    s_waitcnt lgkmcnt(0)
    v_exp_f32 v126, v126
    v_exp_f32 v127, v127
    v_mfma_f32_32x32x16_bf16 v[80:95], a[80:83], a[64:67], v[16:31]
    v_exp_f32 v128, v128
    v_exp_f32 v129, v129
    v_exp_f32 v130, v130
    v_exp_f32 v131, v131
    v_exp_f32 v132, v132
    v_smfmac_f32_32x32x32_bf16 a[32:47], a[100:103], v[120:127], v12
    v_exp_f32 v133, v133
    v_exp_f32 v134, v134
    v_exp_f32 v135, v135
    v_exp_f32 v136, v136
    v_exp_f32 v137, v137
    v_exp_f32 v138, v138
    v_smfmac_f32_32x32x32_bf16 a[48:63], a[96:99], v[128:135], v12
    v_exp_f32 v139, v139
    v_exp_f32 v140, v140
    v_exp_f32 v141, v141
    v_exp_f32 v142, v142
    v_exp_f32 v143, v143
    v_mfma_f32_32x32x16_bf16 v[96:111], a[80:83], a[68:71], v[32:47]
    v_exp_f32 v80, v80
    v_exp_f32 v81, v81
    v_exp_f32 v82, v82
    v_cmp_gt_u32 vcc, s49, v6
    s_cbranch_vccnz L_akc71
    L_akc71_x:
    v_exp_f32 v83, v83
    v_exp_f32 v84, v84
    v_smfmac_f32_32x32x32_bf16 a[48:63], a[100:103], v[136:143], v12
    v_exp_f32 v85, v85
    v_exp_f32 v86, v86
    v_exp_f32 v87, v87
    ds_read_b128 a[92:95], v4 offset:7392
    v_exp_f32 v88, v88
    v_exp_f32 v89, v89
    v_exp_f32 v90, v90
    v_smfmac_f32_32x32x32_bf16 a[0:15], a[84:87], v[80:87], v12
    v_exp_f32 v91, v91
    v_exp_f32 v92, v92
    v_exp_f32 v93, v93
    ds_read_b128 a[96:99], v5 offset:7392
    v_exp_f32 v94, v94
    v_exp_f32 v95, v95
    v_mfma_f32_32x32x16_bf16 v[112:127], a[80:83], a[72:75], v[48:63]
    v_exp_f32 v96, v96
    v_exp_f32 v97, v97
    v_exp_f32 v98, v98
    ds_read_b128 a[100:103], v15 offset:7392
    v_exp_f32 v99, v99
    v_exp_f32 v100, v100
    v_smfmac_f32_32x32x32_bf16 a[0:15], a[88:91], v[88:95], v12
    v_exp_f32 v101, v101
    v_exp_f32 v102, v102
    v_exp_f32 v103, v103
    ds_add_u32 v2, v3 offset:1024
    v_exp_f32 v104, v104
    v_exp_f32 v105, v105
    v_exp_f32 v106, v106
    v_smfmac_f32_32x32x32_bf16 a[16:31], a[84:87], v[96:103], v12
    v_exp_f32 v107, v107
    v_exp_f32 v108, v108
    v_exp_f32 v109, v109
    v_exp_f32 v110, v110
    v_exp_f32 v111, v111
    v_mfma_f32_32x32x16_bf16 v[128:143], a[80:83], a[76:79], v[64:79]
    v_exp_f32 v112, v112
    v_exp_f32 v113, v113
    v_exp_f32 v114, v114
    v_exp_f32 v115, v115
    v_exp_f32 v116, v116
    v_smfmac_f32_32x32x32_bf16 a[16:31], a[88:91], v[104:111], v12
    v_exp_f32 v117, v117
    v_exp_f32 v118, v118
    v_exp_f32 v119, v119
    v_exp_f32 v120, v120
    v_exp_f32 v121, v121
    v_exp_f32 v122, v122
    v_smfmac_f32_32x32x32_bf16 a[32:47], a[84:87], v[112:119], v12
    v_exp_f32 v123, v123
    v_exp_f32 v124, v124
    v_exp_f32 v125, v125
    s_waitcnt lgkmcnt(0)
    v_exp_f32 v126, v126
    v_exp_f32 v127, v127
    v_mfma_f32_32x32x16_bf16 v[80:95], a[92:95], a[64:67], v[16:31]
    v_exp_f32 v128, v128
    v_exp_f32 v129, v129
    v_exp_f32 v130, v130
    v_exp_f32 v131, v131
    v_exp_f32 v132, v132
    v_smfmac_f32_32x32x32_bf16 a[32:47], a[88:91], v[120:127], v12
    v_exp_f32 v133, v133
    v_exp_f32 v134, v134
    v_exp_f32 v135, v135
    v_exp_f32 v136, v136
    v_exp_f32 v137, v137
    v_exp_f32 v138, v138
    v_smfmac_f32_32x32x32_bf16 a[48:63], a[84:87], v[128:135], v12
    v_exp_f32 v139, v139
    v_exp_f32 v140, v140
    v_exp_f32 v141, v141
    v_exp_f32 v142, v142
    v_exp_f32 v143, v143
    v_mfma_f32_32x32x16_bf16 v[96:111], a[92:95], a[68:71], v[32:47]
    v_exp_f32 v80, v80
    v_exp_f32 v81, v81
    v_exp_f32 v82, v82
    ds_read_b128 a[80:83], v4 offset:8448
    v_exp_f32 v83, v83
    v_exp_f32 v84, v84
    v_smfmac_f32_32x32x32_bf16 a[48:63], a[88:91], v[136:143], v12
    v_exp_f32 v85, v85
    v_exp_f32 v86, v86
    v_exp_f32 v87, v87
    ds_read_b128 a[84:87], v5 offset:8448
    v_exp_f32 v88, v88
    v_exp_f32 v89, v89
    v_exp_f32 v90, v90
    v_smfmac_f32_32x32x32_bf16 a[0:15], a[96:99], v[80:87], v12
    v_exp_f32 v91, v91
    v_exp_f32 v92, v92
    v_exp_f32 v93, v93
    ds_read_b128 a[88:91], v15 offset:8448
    v_exp_f32 v94, v94
    v_exp_f32 v95, v95
    v_mfma_f32_32x32x16_bf16 v[112:127], a[92:95], a[72:75], v[48:63]
    v_exp_f32 v96, v96
    v_exp_f32 v97, v97
    v_exp_f32 v98, v98
    ds_read_b32 v6, v0 offset:512
    v_exp_f32 v99, v99
    v_exp_f32 v100, v100
    v_smfmac_f32_32x32x32_bf16 a[0:15], a[100:103], v[88:95], v12
    v_exp_f32 v101, v101
    v_exp_f32 v102, v102
    v_exp_f32 v103, v103
    s_add_u32 s49, s49, 2
    v_exp_f32 v104, v104
    v_exp_f32 v105, v105
    v_exp_f32 v106, v106
    v_smfmac_f32_32x32x32_bf16 a[16:31], a[96:99], v[96:103], v12
    v_exp_f32 v107, v107
    v_exp_f32 v108, v108
    v_exp_f32 v109, v109
    v_exp_f32 v110, v110
    v_exp_f32 v111, v111
    v_mfma_f32_32x32x16_bf16 v[128:143], a[92:95], a[76:79], v[64:79]
    v_exp_f32 v112, v112
    v_exp_f32 v113, v113
    v_exp_f32 v114, v114
    v_exp_f32 v115, v115
    v_exp_f32 v116, v116
    v_smfmac_f32_32x32x32_bf16 a[16:31], a[100:103], v[104:111], v12
    v_exp_f32 v117, v117
    v_exp_f32 v118, v118
    v_exp_f32 v119, v119
    v_exp_f32 v120, v120
    v_exp_f32 v121, v121
    v_exp_f32 v122, v122
    v_smfmac_f32_32x32x32_bf16 a[32:47], a[96:99], v[112:119], v12
    v_exp_f32 v123, v123
    v_exp_f32 v124, v124
    v_exp_f32 v125, v125
    s_waitcnt lgkmcnt(0)
    v_exp_f32 v126, v126
    v_exp_f32 v127, v127
    v_mfma_f32_32x32x16_bf16 v[80:95], a[80:83], a[64:67], v[16:31]
    v_exp_f32 v128, v128
    v_exp_f32 v129, v129
    v_exp_f32 v130, v130
    v_exp_f32 v131, v131
    v_exp_f32 v132, v132
    v_smfmac_f32_32x32x32_bf16 a[32:47], a[100:103], v[120:127], v12
    v_exp_f32 v133, v133
    v_exp_f32 v134, v134
    v_exp_f32 v135, v135
    v_exp_f32 v136, v136
    v_exp_f32 v137, v137
    v_exp_f32 v138, v138
    v_smfmac_f32_32x32x32_bf16 a[48:63], a[96:99], v[128:135], v12
    v_exp_f32 v139, v139
    v_exp_f32 v140, v140
    v_exp_f32 v141, v141
    v_exp_f32 v142, v142
    v_exp_f32 v143, v143
    v_mfma_f32_32x32x16_bf16 v[96:111], a[80:83], a[68:71], v[32:47]
    v_exp_f32 v80, v80
    v_exp_f32 v81, v81
    v_exp_f32 v82, v82
    v_cmp_gt_u32 vcc, s49, v6
    s_cbranch_vccnz L_akc72
    L_akc72_x:
    v_exp_f32 v83, v83
    v_exp_f32 v84, v84
    v_smfmac_f32_32x32x32_bf16 a[48:63], a[100:103], v[136:143], v12
    v_exp_f32 v85, v85
    v_exp_f32 v86, v86
    v_exp_f32 v87, v87
    ds_read_b128 a[92:95], v4 offset:9504
    v_exp_f32 v88, v88
    v_exp_f32 v89, v89
    v_exp_f32 v90, v90
    v_smfmac_f32_32x32x32_bf16 a[0:15], a[84:87], v[80:87], v12
    v_exp_f32 v91, v91
    v_exp_f32 v92, v92
    v_exp_f32 v93, v93
    ds_read_b128 a[96:99], v5 offset:9504
    v_exp_f32 v94, v94
    v_exp_f32 v95, v95
    v_mfma_f32_32x32x16_bf16 v[112:127], a[80:83], a[72:75], v[48:63]
    v_exp_f32 v96, v96
    v_exp_f32 v97, v97
    v_exp_f32 v98, v98
    ds_read_b128 a[100:103], v15 offset:9504
    v_exp_f32 v99, v99
    v_exp_f32 v100, v100
    v_smfmac_f32_32x32x32_bf16 a[0:15], a[88:91], v[88:95], v12
    v_exp_f32 v101, v101
    v_exp_f32 v102, v102
    v_exp_f32 v103, v103
    ds_add_u32 v2, v3 offset:1024
    v_exp_f32 v104, v104
    v_exp_f32 v105, v105
    v_exp_f32 v106, v106
    v_smfmac_f32_32x32x32_bf16 a[16:31], a[84:87], v[96:103], v12
    v_exp_f32 v107, v107
    v_exp_f32 v108, v108
    v_exp_f32 v109, v109
    v_exp_f32 v110, v110
    v_exp_f32 v111, v111
    v_mfma_f32_32x32x16_bf16 v[128:143], a[80:83], a[76:79], v[64:79]
    v_exp_f32 v112, v112
    v_exp_f32 v113, v113
    v_exp_f32 v114, v114
    v_exp_f32 v115, v115
    v_exp_f32 v116, v116
    v_smfmac_f32_32x32x32_bf16 a[16:31], a[88:91], v[104:111], v12
    v_exp_f32 v117, v117
    v_exp_f32 v118, v118
    v_exp_f32 v119, v119
    v_exp_f32 v120, v120
    v_exp_f32 v121, v121
    v_exp_f32 v122, v122
    v_smfmac_f32_32x32x32_bf16 a[32:47], a[84:87], v[112:119], v12
    v_exp_f32 v123, v123
    v_exp_f32 v124, v124
    v_exp_f32 v125, v125
    s_waitcnt lgkmcnt(0)
    v_exp_f32 v126, v126
    v_exp_f32 v127, v127
    v_mfma_f32_32x32x16_bf16 v[80:95], a[92:95], a[64:67], v[16:31]
    v_exp_f32 v128, v128
    v_exp_f32 v129, v129
    v_exp_f32 v130, v130
    v_exp_f32 v131, v131
    v_exp_f32 v132, v132
    v_smfmac_f32_32x32x32_bf16 a[32:47], a[88:91], v[120:127], v12
    v_exp_f32 v133, v133
    v_exp_f32 v134, v134
    v_exp_f32 v135, v135
    v_exp_f32 v136, v136
    v_exp_f32 v137, v137
    v_exp_f32 v138, v138
    v_smfmac_f32_32x32x32_bf16 a[48:63], a[84:87], v[128:135], v12
    v_exp_f32 v139, v139
    v_exp_f32 v140, v140
    v_exp_f32 v141, v141
    v_exp_f32 v142, v142
    v_exp_f32 v143, v143
    v_mfma_f32_32x32x16_bf16 v[96:111], a[92:95], a[68:71], v[32:47]
    v_exp_f32 v80, v80
    v_exp_f32 v81, v81
    v_exp_f32 v82, v82
    ds_read_b128 a[80:83], v4 offset:0
    v_exp_f32 v83, v83
    v_exp_f32 v84, v84
    v_smfmac_f32_32x32x32_bf16 a[48:63], a[88:91], v[136:143], v12
    v_exp_f32 v85, v85
    v_exp_f32 v86, v86
    v_exp_f32 v87, v87
    ds_read_b128 a[84:87], v5 offset:0
    v_exp_f32 v88, v88
    v_exp_f32 v89, v89
    v_exp_f32 v90, v90
    v_smfmac_f32_32x32x32_bf16 a[0:15], a[96:99], v[80:87], v12
    v_exp_f32 v91, v91
    v_exp_f32 v92, v92
    v_exp_f32 v93, v93
    ds_read_b128 a[88:91], v15 offset:0
    v_exp_f32 v94, v94
    v_exp_f32 v95, v95
    v_mfma_f32_32x32x16_bf16 v[112:127], a[92:95], a[72:75], v[48:63]
    v_exp_f32 v96, v96
    v_exp_f32 v97, v97
    v_exp_f32 v98, v98
    ds_read_b32 v6, v0 offset:512
    v_exp_f32 v99, v99
    v_exp_f32 v100, v100
    v_smfmac_f32_32x32x32_bf16 a[0:15], a[100:103], v[88:95], v12
    v_exp_f32 v101, v101
    v_exp_f32 v102, v102
    v_exp_f32 v103, v103
    s_add_u32 s49, s49, 2
    v_exp_f32 v104, v104
    v_exp_f32 v105, v105
    v_exp_f32 v106, v106
    v_smfmac_f32_32x32x32_bf16 a[16:31], a[96:99], v[96:103], v12
    v_exp_f32 v107, v107
    v_exp_f32 v108, v108
    v_exp_f32 v109, v109
    v_exp_f32 v110, v110
    v_exp_f32 v111, v111
    v_mfma_f32_32x32x16_bf16 v[128:143], a[92:95], a[76:79], v[64:79]
    v_exp_f32 v112, v112
    v_exp_f32 v113, v113
    v_exp_f32 v114, v114
    v_exp_f32 v115, v115
    v_exp_f32 v116, v116
    v_smfmac_f32_32x32x32_bf16 a[16:31], a[100:103], v[104:111], v12
    v_exp_f32 v117, v117
    v_exp_f32 v118, v118
    v_exp_f32 v119, v119
    v_exp_f32 v120, v120
    v_exp_f32 v121, v121
    v_exp_f32 v122, v122
    v_smfmac_f32_32x32x32_bf16 a[32:47], a[96:99], v[112:119], v12
    v_exp_f32 v123, v123
    v_exp_f32 v124, v124
    v_exp_f32 v125, v125
    s_waitcnt lgkmcnt(0)
    v_exp_f32 v126, v126
    v_exp_f32 v127, v127
    v_mfma_f32_32x32x16_bf16 v[80:95], a[80:83], a[64:67], v[16:31]
    v_exp_f32 v128, v128
    v_exp_f32 v129, v129
    v_exp_f32 v130, v130
    s_sub_u32 s51, s51, 1
    v_exp_f32 v131, v131
    v_exp_f32 v132, v132
    v_smfmac_f32_32x32x32_bf16 a[32:47], a[100:103], v[120:127], v12
    v_exp_f32 v133, v133
    v_exp_f32 v134, v134
    v_exp_f32 v135, v135
    s_cmp_lg_u32 s51, 0
    v_exp_f32 v136, v136
    v_exp_f32 v137, v137
    v_exp_f32 v138, v138
    v_smfmac_f32_32x32x32_bf16 a[48:63], a[96:99], v[128:135], v12
    v_exp_f32 v139, v139
    v_exp_f32 v140, v140
    v_exp_f32 v141, v141
    v_exp_f32 v142, v142
    v_exp_f32 v143, v143
    s_cbranch_scc1 L_aloop
    v_mfma_f32_32x32x16_bf16 v[96:111], a[80:83], a[68:71], v[32:47]
    v_exp_f32 v80, v80
    v_exp_f32 v81, v81
    v_exp_f32 v82, v82
    v_exp_f32 v83, v83
    v_exp_f32 v84, v84
    v_smfmac_f32_32x32x32_bf16 a[48:63], a[100:103], v[136:143], v12
    v_exp_f32 v85, v85
    v_cmp_gt_u32 vcc, 32, v6
    s_cbranch_vccnz L_akc73
L_akc73_x:
    ds_add_u32 v2, v3 offset:1024
    ds_read_b128 a[92:95], v4 offset:1056
    ds_read_b128 a[96:99], v5 offset:1056
    ds_read_b128 a[100:103], v15 offset:1056
    v_exp_f32 v86, v86
    v_exp_f32 v87, v87
    v_exp_f32 v88, v88
    v_exp_f32 v89, v89
    v_exp_f32 v90, v90
    v_smfmac_f32_32x32x32_bf16 a[0:15], a[84:87], v[80:87], v12
    v_exp_f32 v91, v91
    v_exp_f32 v92, v92
    v_exp_f32 v93, v93
    v_exp_f32 v94, v94
    v_exp_f32 v95, v95
    s_waitcnt lgkmcnt(0)
    v_mfma_f32_32x32x16_bf16 v[112:127], a[92:95], a[64:67], v[16:31]
    v_exp_f32 v96, v96
    v_exp_f32 v97, v97
    v_exp_f32 v98, v98
    v_exp_f32 v99, v99
    v_exp_f32 v100, v100
    v_smfmac_f32_32x32x32_bf16 a[0:15], a[88:91], v[88:95], v12
    v_exp_f32 v101, v101
    v_exp_f32 v102, v102
    s_mul_i32 s43, s40, 4608
    s_add_u32 s43, s43, 140544
    v_add_u32 v72, s43, v10
    v_lshl_add_u32 v73, v1, 2, s43
    v_mov_b32 v74, s50
    v_exp_f32 v103, v103
    ds_write_b128 v72, a[32:35] offset:0
    v_exp_f32 v104, v104
    ds_write_b128 v72, a[36:39] offset:1024
    v_exp_f32 v105, v105
    ds_write_b32 v73, a40 offset:2048
    v_exp_f32 v106, v106
    ds_write_b128 v72, a[48:51] offset:2304
    v_smfmac_f32_32x32x32_bf16 a[16:31], a[84:87], v[96:103], v12
    v_exp_f32 v107, v107
    v_exp_f32 v108, v108
    v_exp_f32 v109, v109
    v_exp_f32 v110, v110
    v_exp_f32 v111, v111
    v_mfma_f32_32x32x16_bf16 v[128:143], a[92:95], a[68:71], v[32:47]
    v_exp_f32 v112, v112
    v_exp_f32 v113, v113
    v_exp_f32 v114, v114
    v_exp_f32 v115, v115
    v_exp_f32 v116, v116
    v_smfmac_f32_32x32x32_bf16 a[16:31], a[88:91], v[104:111], v12
    v_exp_f32 v117, v117
    ds_read_b128 a[80:83], v7 offset:0
    ds_read_b128 a[84:87], v8 offset:0
    ds_read_b128 a[88:91], v9 offset:0
    v_exp_f32 v118, v118
    v_exp_f32 v119, v119
    v_exp_f32 v120, v120
    v_exp_f32 v121, v121
    v_exp_f32 v122, v122
    v_smfmac_f32_32x32x32_bf16 a[0:15], a[96:99], v[112:119], v12
    v_exp_f32 v123, v123
    v_exp_f32 v124, v124
    v_exp_f32 v125, v125
    v_exp_f32 v126, v126
    v_exp_f32 v127, v127
    s_waitcnt lgkmcnt(0)
    v_mfma_f32_32x32x16_bf16 v[80:95], a[80:83], a[64:67], v[16:31]
    v_exp_f32 v128, v128
    v_exp_f32 v129, v129
    v_exp_f32 v130, v130
    v_exp_f32 v131, v131
    v_exp_f32 v132, v132
    v_smfmac_f32_32x32x32_bf16 a[0:15], a[100:103], v[120:127], v12
    v_exp_f32 v133, v133
    v_exp_f32 v134, v134
    ds_write_b128 v72, a[52:55] offset:3328
    v_exp_f32 v135, v135
    ds_write_b32 v73, a56 offset:4352
    v_exp_f32 v136, v136
    ds_write_b32 v13, v74
    v_exp_f32 v137, v137
    s_xor_b32 s43, s40, 2
    s_mul_i32 s43, s43, 4608
    s_add_u32 s43, s43, 140544
    v_add_u32 v75, s43, v10
    v_lshl_add_u32 v76, v1, 2, s43
    v_exp_f32 v138, v138
    v_smfmac_f32_32x32x32_bf16 a[16:31], a[96:99], v[128:135], v12
    v_exp_f32 v139, v139
    v_exp_f32 v140, v140
    v_exp_f32 v141, v141
    v_exp_f32 v142, v142
    v_exp_f32 v143, v143
    v_mfma_f32_32x32x16_bf16 v[96:111], a[80:83], a[68:71], v[32:47]
    v_exp_f32 v80, v80
    v_exp_f32 v81, v81
    v_exp_f32 v82, v82
    v_exp_f32 v83, v83
    v_exp_f32 v84, v84
    v_smfmac_f32_32x32x32_bf16 a[16:31], a[100:103], v[136:143], v12
    v_exp_f32 v85, v85
    ds_read_b128 a[92:95], v7 offset:1056
    ds_read_b128 a[96:99], v8 offset:1056
    ds_read_b128 a[100:103], v9 offset:1056
    v_exp_f32 v86, v86
    v_exp_f32 v87, v87
    v_exp_f32 v88, v88
    v_exp_f32 v89, v89
    v_exp_f32 v90, v90
    v_smfmac_f32_32x32x32_bf16 a[0:15], a[84:87], v[80:87], v12
    v_exp_f32 v91, v91
    v_exp_f32 v92, v92
    v_exp_f32 v93, v93
    v_exp_f32 v94, v94
    v_exp_f32 v95, v95
    s_waitcnt lgkmcnt(0)
    v_mfma_f32_32x32x16_bf16 v[112:127], a[92:95], a[64:67], v[16:31]
    v_exp_f32 v96, v96
    v_exp_f32 v97, v97
    v_exp_f32 v98, v98
    v_exp_f32 v99, v99
    v_exp_f32 v100, v100
    v_smfmac_f32_32x32x32_bf16 a[0:15], a[88:91], v[88:95], v12
    v_exp_f32 v101, v101
    v_exp_f32 v102, v102
    v_exp_f32 v103, v103
    v_exp_f32 v104, v104
    v_exp_f32 v105, v105
    v_exp_f32 v106, v106
    v_smfmac_f32_32x32x32_bf16 a[16:31], a[84:87], v[96:103], v12
    v_exp_f32 v107, v107
    v_exp_f32 v108, v108
    v_exp_f32 v109, v109
    v_exp_f32 v110, v110
    v_exp_f32 v111, v111
    v_mfma_f32_32x32x16_bf16 v[128:143], a[92:95], a[68:71], v[32:47]
    v_exp_f32 v112, v112
    v_exp_f32 v113, v113
    v_exp_f32 v114, v114
    v_exp_f32 v115, v115
    v_exp_f32 v116, v116
    v_smfmac_f32_32x32x32_bf16 a[16:31], a[88:91], v[104:111], v12
    v_exp_f32 v117, v117
L_ax74:
    ds_read_b32 v6, v14 offset:0
    s_waitcnt lgkmcnt(0)
    v_cmp_gt_u32 vcc, s50, v6
    s_cbranch_vccz L_ax74_x
    s_sub_u32 s47, s47, 1
    s_cmp_lt_i32 s47, 0
    s_cbranch_scc1 L_ax74_x
    s_branch L_ax74
L_ax74_x:
    ds_read_b128 v[48:51], v75 offset:0
    ds_read_b128 v[52:55], v75 offset:1024
    ds_read_b32 v56, v76 offset:2048
    ds_read_b128 v[60:63], v75 offset:2304
    ds_read_b128 v[64:67], v75 offset:3328
    ds_read_b32 v68, v76 offset:4352
    v_exp_f32 v118, v118
    v_exp_f32 v119, v119
    v_exp_f32 v120, v120
    v_exp_f32 v121, v121
    v_exp_f32 v122, v122
    v_smfmac_f32_32x32x32_bf16 a[0:15], a[96:99], v[112:119], v12
    v_exp_f32 v123, v123
    v_exp_f32 v124, v124
    v_exp_f32 v125, v125
    v_exp_f32 v126, v126
    v_exp_f32 v127, v127
    v_exp_f32 v128, v128
    v_exp_f32 v129, v129
    v_exp_f32 v130, v130
    v_exp_f32 v131, v131
    v_exp_f32 v132, v132
    v_smfmac_f32_32x32x32_bf16 a[0:15], a[100:103], v[120:127], v12
    v_exp_f32 v133, v133
    v_exp_f32 v134, v134
    v_exp_f32 v135, v135
    v_exp_f32 v136, v136
    v_exp_f32 v137, v137
    v_exp_f32 v138, v138
    v_smfmac_f32_32x32x32_bf16 a[16:31], a[96:99], v[128:135], v12
    v_exp_f32 v139, v139
    v_exp_f32 v140, v140
    v_exp_f32 v141, v141
    v_exp_f32 v142, v142
    v_exp_f32 v143, v143
    s_nop 2
    v_smfmac_f32_32x32x32_bf16 a[16:31], a[100:103], v[136:143], v12
L_afin:
    v_accvgpr_read_b32 v16, a0
    v_accvgpr_read_b32 v17, a1
    v_accvgpr_read_b32 v18, a2
    v_accvgpr_read_b32 v19, a3
    v_accvgpr_read_b32 v20, a4
    v_accvgpr_read_b32 v21, a5
    v_accvgpr_read_b32 v22, a6
    v_accvgpr_read_b32 v23, a7
    v_accvgpr_read_b32 v24, a8
    s_nop 2
    v_accvgpr_read_b32 v28, a16
    v_accvgpr_read_b32 v29, a17
    v_accvgpr_read_b32 v30, a18
    v_accvgpr_read_b32 v31, a19
    v_accvgpr_read_b32 v32, a20
    v_accvgpr_read_b32 v33, a21
    v_accvgpr_read_b32 v34, a22
    v_accvgpr_read_b32 v35, a23
    v_accvgpr_read_b32 v36, a24
    v_mov_b32 v2, 0
    v_mov_b32 v3, 0
    s_mov_b32 s4, 0x8800000
    s_mov_b32 s5, 0x7b800000
    s_add_u32 s6, s60, 32768
    s_waitcnt lgkmcnt(0)
    v_add_f32 v24, v24, v56
    v_add_f32 v36, v36, v68
    v_rcp_f32 v26, v24
    v_rcp_f32 v38, v36
    v_pk_add_f32 v[16:17], v[16:17], v[48:49]
    v_pk_add_f32 v[18:19], v[18:19], v[50:51]
    v_pk_add_f32 v[20:21], v[20:21], v[52:53]
    v_pk_add_f32 v[22:23], v[22:23], v[54:55]
    v_pk_add_f32 v[28:29], v[28:29], v[60:61]
    v_pk_add_f32 v[30:31], v[30:31], v[62:63]
    v_pk_add_f32 v[32:33], v[32:33], v[64:65]
    v_pk_add_f32 v[34:35], v[34:35], v[66:67]
    v_min_f32 v4, v24, v36
    v_max_f32 v5, v24, v36
    v_cmp_nle_f32 s[52:53], s4, v4
    v_cmp_nge_f32 vcc, s5, v5
    v_pk_mul_f32 v[16:17], v[16:17], v[26:27] op_sel_hi:[1,0]
    v_pk_mul_f32 v[18:19], v[18:19], v[26:27] op_sel_hi:[1,0]
    v_pk_mul_f32 v[20:21], v[20:21], v[26:27] op_sel_hi:[1,0]
    v_pk_mul_f32 v[22:23], v[22:23], v[26:27] op_sel_hi:[1,0]
    v_pk_mul_f32 v[28:29], v[28:29], v[38:39] op_sel_hi:[1,0]
    v_pk_mul_f32 v[30:31], v[30:31], v[38:39] op_sel_hi:[1,0]
    v_pk_mul_f32 v[32:33], v[32:33], v[38:39] op_sel_hi:[1,0]
    v_pk_mul_f32 v[34:35], v[34:35], v[38:39] op_sel_hi:[1,0]
    s_or_b64 s[52:53], s[52:53], vcc
    v_pk_fma_f32 v[2:3], v[16:17], 0, v[2:3] op_sel_hi:[1,0,1]
    v_pk_fma_f32 v[2:3], v[18:19], 0, v[2:3] op_sel_hi:[1,0,1]
    v_pk_fma_f32 v[2:3], v[20:21], 0, v[2:3] op_sel_hi:[1,0,1]
    v_pk_fma_f32 v[2:3], v[22:23], 0, v[2:3] op_sel_hi:[1,0,1]
    v_pk_fma_f32 v[2:3], v[28:29], 0, v[2:3] op_sel_hi:[1,0,1]
    v_pk_fma_f32 v[2:3], v[30:31], 0, v[2:3] op_sel_hi:[1,0,1]
    v_pk_fma_f32 v[2:3], v[32:33], 0, v[2:3] op_sel_hi:[1,0,1]
    v_pk_fma_f32 v[2:3], v[34:35], 0, v[2:3] op_sel_hi:[1,0,1]
    v_cvt_pk_bf16_f32 v48, v16, v17
    v_cvt_pk_bf16_f32 v49, v18, v19
    v_cvt_pk_bf16_f32 v50, v20, v21
    v_cvt_pk_bf16_f32 v51, v22, v23
    v_cvt_pk_bf16_f32 v60, v28, v29
    v_cvt_pk_bf16_f32 v61, v30, v31
    v_cvt_pk_bf16_f32 v62, v32, v33
    v_cvt_pk_bf16_f32 v63, v34, v35
    v_cmp_u_f32 vcc, v2, v3
    v_min_u32 v48, -2, v48
    v_min_u32 v49, -2, v49
    v_min_u32 v50, -2, v50
    v_min_u32 v51, -2, v51
    v_min_u32 v60, -2, v60
    v_min_u32 v61, -2, v61
    v_min_u32 v62, -2, v62
    v_min_u32 v63, -2, v63
    s_or_b64 s[52:53], s[52:53], vcc
    s_cselect_b32 s4, 2, 1
    s_cmp_eq_u32 s50, 2
    s_cselect_b32 s5, 1, s4
    s_or_b32 s5, s5, s62
    s_cmp_lg_u32 s5, 1
    s_cbranch_scc1 L_anost
    buffer_store_dwordx4 v[48:51], v10, s[28:31], s60 offen sc1
    buffer_store_dwordx4 v[60:63], v10, s[28:31], s6 offen sc1
    s_mov_b32 s62, 2
L_anost:
    v_mov_b32 v2, s4
    ds_write_b32 v13, v2 offset:256
L_anoflag:
    s_cmp_eq_u32 s50, 2
    s_cbranch_scc1 L_end
L_as:
    ds_read_b32 v6, v14 offset:256
    s_waitcnt lgkmcnt(0)
    v_cmp_eq_u32 vcc, 0, v6
    s_cbranch_vccz L_as_x
    s_sub_u32 s47, s47, 1
    s_cmp_lt_i32 s47, 0
    s_cbranch_scc1 L_as_x
    s_branch L_as
L_as_x:
    v_readfirstlane_b32 s5, v6
    s_max_u32 s4, s4, s5
    s_cmp_lt_u32 s4, 2
    s_cbranch_scc0 L_afb0
    s_endpgm
L_afb0:
    s_mov_b32 s50, 2
    s_mov_b32 s54, 0
    s_mov_b32 s51, 64
    s_mov_b32 s48, s61
    s_waitcnt vmcnt(0)
    v_mov_b32 v6, 0xff800000
    v_mov_b32 v7, 0xff800000
    v_mov_b32 v8, 0xff800000
    v_mov_b32 v9, 0xff800000
L_afb:
    buffer_load_dwordx4 a[104:107], v10, s[28:31], s48 offen sc1
    s_waitcnt vmcnt(0)
    v_mfma_f32_32x32x16_bf16 v[16:31], a[104:107], a[64:67], 0
    v_mfma_f32_32x32x16_bf16 v[32:47], a[104:107], a[68:71], 0
    v_mfma_f32_32x32x16_bf16 v[48:63], a[104:107], a[72:75], 0
    v_mfma_f32_32x32x16_bf16 v[64:79], a[104:107], a[76:79], 0
    s_nop 11
    v_max3_f32 v6, v6, v16, v17
    v_max3_f32 v6, v6, v18, v19
    v_max3_f32 v6, v6, v20, v21
    v_max3_f32 v6, v6, v22, v23
    v_max3_f32 v6, v6, v24, v25
    v_max3_f32 v6, v6, v26, v27
    v_max3_f32 v6, v6, v28, v29
    v_max3_f32 v6, v6, v30, v31
    v_max3_f32 v7, v7, v32, v33
    v_max3_f32 v7, v7, v34, v35
    v_max3_f32 v7, v7, v36, v37
    v_max3_f32 v7, v7, v38, v39
    v_max3_f32 v7, v7, v40, v41
    v_max3_f32 v7, v7, v42, v43
    v_max3_f32 v7, v7, v44, v45
    v_max3_f32 v7, v7, v46, v47
    v_max3_f32 v8, v8, v48, v49
    v_max3_f32 v8, v8, v50, v51
    v_max3_f32 v8, v8, v52, v53
    v_max3_f32 v8, v8, v54, v55
    v_max3_f32 v8, v8, v56, v57
    v_max3_f32 v8, v8, v58, v59
    v_max3_f32 v8, v8, v60, v61
    v_max3_f32 v8, v8, v62, v63
    v_max3_f32 v9, v9, v64, v65
    v_max3_f32 v9, v9, v66, v67
    v_max3_f32 v9, v9, v68, v69
    v_max3_f32 v9, v9, v70, v71
    v_max3_f32 v9, v9, v72, v73
    v_max3_f32 v9, v9, v74, v75
    v_max3_f32 v9, v9, v76, v77
    v_max3_f32 v9, v9, v78, v79
    s_add_u32 s48, s48, 1024
    s_sub_u32 s51, s51, 1
    s_cmp_lg_u32 s51, 0
    s_cbranch_scc1 L_afb
    v_mov_b32 v80, v6
    v_mov_b32 v81, v7
    v_mov_b32 v82, v8
    v_mov_b32 v83, v9
    s_nop 1
    v_permlane32_swap_b32 v80, v6
    v_permlane32_swap_b32 v81, v7
    v_permlane32_swap_b32 v82, v8
    v_permlane32_swap_b32 v83, v9
    v_max_f32 v6, v6, v80
    v_max_f32 v7, v7, v81
    v_max_f32 v8, v8, v82
    v_max_f32 v9, v9, v83
    v_sub_f32 v6, s54, v6
    v_sub_f32 v7, s54, v7
    v_sub_f32 v8, s54, v8
    v_sub_f32 v9, s54, v9
    v_pk_mov_b32 v[16:17], v[6:7], v[6:7] op_sel:[0,0]
    v_pk_mov_b32 v[18:19], v[6:7], v[6:7] op_sel:[0,0]
    v_pk_mov_b32 v[20:21], v[6:7], v[6:7] op_sel:[0,0]
    v_pk_mov_b32 v[22:23], v[6:7], v[6:7] op_sel:[0,0]
    v_pk_mov_b32 v[24:25], v[6:7], v[6:7] op_sel:[0,0]
    v_pk_mov_b32 v[26:27], v[6:7], v[6:7] op_sel:[0,0]
    v_pk_mov_b32 v[28:29], v[6:7], v[6:7] op_sel:[0,0]
    v_pk_mov_b32 v[30:31], v[6:7], v[6:7] op_sel:[0,0]
    v_pk_mov_b32 v[32:33], v[6:7], v[6:7] op_sel:[1,1]
    v_pk_mov_b32 v[34:35], v[6:7], v[6:7] op_sel:[1,1]
    v_pk_mov_b32 v[36:37], v[6:7], v[6:7] op_sel:[1,1]
    v_pk_mov_b32 v[38:39], v[6:7], v[6:7] op_sel:[1,1]
    v_pk_mov_b32 v[40:41], v[6:7], v[6:7] op_sel:[1,1]
    v_pk_mov_b32 v[42:43], v[6:7], v[6:7] op_sel:[1,1]
    v_pk_mov_b32 v[44:45], v[6:7], v[6:7] op_sel:[1,1]
    v_pk_mov_b32 v[46:47], v[6:7], v[6:7] op_sel:[1,1]
    v_pk_mov_b32 v[48:49], v[8:9], v[8:9] op_sel:[0,0]
    v_pk_mov_b32 v[50:51], v[8:9], v[8:9] op_sel:[0,0]
    v_pk_mov_b32 v[52:53], v[8:9], v[8:9] op_sel:[0,0]
    v_pk_mov_b32 v[54:55], v[8:9], v[8:9] op_sel:[0,0]
    v_pk_mov_b32 v[56:57], v[8:9], v[8:9] op_sel:[0,0]
    v_pk_mov_b32 v[58:59], v[8:9], v[8:9] op_sel:[0,0]
    v_pk_mov_b32 v[60:61], v[8:9], v[8:9] op_sel:[0,0]
    v_pk_mov_b32 v[62:63], v[8:9], v[8:9] op_sel:[0,0]
    v_pk_mov_b32 v[64:65], v[8:9], v[8:9] op_sel:[1,1]
    v_pk_mov_b32 v[66:67], v[8:9], v[8:9] op_sel:[1,1]
    v_pk_mov_b32 v[68:69], v[8:9], v[8:9] op_sel:[1,1]
    v_pk_mov_b32 v[70:71], v[8:9], v[8:9] op_sel:[1,1]
    v_pk_mov_b32 v[72:73], v[8:9], v[8:9] op_sel:[1,1]
    v_pk_mov_b32 v[74:75], v[8:9], v[8:9] op_sel:[1,1]
    v_pk_mov_b32 v[76:77], v[8:9], v[8:9] op_sel:[1,1]
    v_pk_mov_b32 v[78:79], v[8:9], v[8:9] op_sel:[1,1]
    v_accvgpr_write_b32 a0, 0
    v_accvgpr_write_b32 a1, 0
    v_accvgpr_write_b32 a2, 0
    v_accvgpr_write_b32 a3, 0
    v_accvgpr_write_b32 a4, 0
    v_accvgpr_write_b32 a5, 0
    v_accvgpr_write_b32 a6, 0
    v_accvgpr_write_b32 a7, 0
    v_accvgpr_write_b32 a8, 0
    v_accvgpr_write_b32 a9, 0
    v_accvgpr_write_b32 a10, 0
    v_accvgpr_write_b32 a11, 0
    v_accvgpr_write_b32 a12, 0
    v_accvgpr_write_b32 a13, 0
    v_accvgpr_write_b32 a14, 0
    v_accvgpr_write_b32 a15, 0
    v_accvgpr_write_b32 a16, 0
    v_accvgpr_write_b32 a17, 0
    v_accvgpr_write_b32 a18, 0
    v_accvgpr_write_b32 a19, 0
    v_accvgpr_write_b32 a20, 0
    v_accvgpr_write_b32 a21, 0
    v_accvgpr_write_b32 a22, 0
    v_accvgpr_write_b32 a23, 0
    v_accvgpr_write_b32 a24, 0
    v_accvgpr_write_b32 a25, 0
    v_accvgpr_write_b32 a26, 0
    v_accvgpr_write_b32 a27, 0
    v_accvgpr_write_b32 a28, 0
    v_accvgpr_write_b32 a29, 0
    v_accvgpr_write_b32 a30, 0
    v_accvgpr_write_b32 a31, 0
    v_accvgpr_write_b32 a32, 0
    v_accvgpr_write_b32 a33, 0
    v_accvgpr_write_b32 a34, 0
    v_accvgpr_write_b32 a35, 0
    v_accvgpr_write_b32 a36, 0
    v_accvgpr_write_b32 a37, 0
    v_accvgpr_write_b32 a38, 0
    v_accvgpr_write_b32 a39, 0
    v_accvgpr_write_b32 a40, 0
    v_accvgpr_write_b32 a41, 0
    v_accvgpr_write_b32 a42, 0
    v_accvgpr_write_b32 a43, 0
    v_accvgpr_write_b32 a44, 0
    v_accvgpr_write_b32 a45, 0
    v_accvgpr_write_b32 a46, 0
    v_accvgpr_write_b32 a47, 0
    v_accvgpr_write_b32 a48, 0
    v_accvgpr_write_b32 a49, 0
    v_accvgpr_write_b32 a50, 0
    v_accvgpr_write_b32 a51, 0
    v_accvgpr_write_b32 a52, 0
    v_accvgpr_write_b32 a53, 0
    v_accvgpr_write_b32 a54, 0
    v_accvgpr_write_b32 a55, 0
    v_accvgpr_write_b32 a56, 0
    v_accvgpr_write_b32 a57, 0
    v_accvgpr_write_b32 a58, 0
    v_accvgpr_write_b32 a59, 0
    v_accvgpr_write_b32 a60, 0
    v_accvgpr_write_b32 a61, 0
    v_accvgpr_write_b32 a62, 0
    v_accvgpr_write_b32 a63, 0
    s_mov_b32 s51, 32
    s_mov_b32 s48, s56
L_afb2:
    buffer_load_dwordx4 a[80:83], v10, s[28:31], s48 offen sc1
    s_mov_b64 exec, s[58:59]
    buffer_load_dwordx4 a[84:87], v11, s[28:31], s48 offen sc1
    buffer_load_dwordx4 a[88:91], v11, s[28:31], s48 offen offset:512 sc1
    s_mov_b64 exec, -1
    s_waitcnt vmcnt(0)
    v_mfma_f32_32x32x16_bf16 v[80:95], a[80:83], a[64:67], v[16:31]
    v_mfma_f32_32x32x16_bf16 v[96:111], a[80:83], a[68:71], v[32:47]
    v_mfma_f32_32x32x16_bf16 v[112:127], a[80:83], a[72:75], v[48:63]
    v_mfma_f32_32x32x16_bf16 v[128:143], a[80:83], a[76:79], v[64:79]
    s_nop 8
    v_exp_f32 v80, v80
    v_exp_f32 v81, v81
    v_exp_f32 v82, v82
    v_exp_f32 v83, v83
    v_exp_f32 v84, v84
    v_exp_f32 v85, v85
    v_exp_f32 v86, v86
    v_exp_f32 v87, v87
    v_exp_f32 v88, v88
    v_exp_f32 v89, v89
    v_exp_f32 v90, v90
    v_exp_f32 v91, v91
    v_exp_f32 v92, v92
    v_exp_f32 v93, v93
    v_exp_f32 v94, v94
    v_exp_f32 v95, v95
    v_exp_f32 v96, v96
    v_exp_f32 v97, v97
    v_exp_f32 v98, v98
    v_exp_f32 v99, v99
    v_exp_f32 v100, v100
    v_exp_f32 v101, v101
    v_exp_f32 v102, v102
    v_exp_f32 v103, v103
    v_exp_f32 v104, v104
    v_exp_f32 v105, v105
    v_exp_f32 v106, v106
    v_exp_f32 v107, v107
    v_exp_f32 v108, v108
    v_exp_f32 v109, v109
    v_exp_f32 v110, v110
    v_exp_f32 v111, v111
    v_exp_f32 v112, v112
    v_exp_f32 v113, v113
    v_exp_f32 v114, v114
    v_exp_f32 v115, v115
    v_exp_f32 v116, v116
    v_exp_f32 v117, v117
    v_exp_f32 v118, v118
    v_exp_f32 v119, v119
    v_exp_f32 v120, v120
    v_exp_f32 v121, v121
    v_exp_f32 v122, v122
    v_exp_f32 v123, v123
    v_exp_f32 v124, v124
    v_exp_f32 v125, v125
    v_exp_f32 v126, v126
    v_exp_f32 v127, v127
    v_exp_f32 v128, v128
    v_exp_f32 v129, v129
    v_exp_f32 v130, v130
    v_exp_f32 v131, v131
    v_exp_f32 v132, v132
    v_exp_f32 v133, v133
    v_exp_f32 v134, v134
    v_exp_f32 v135, v135
    v_exp_f32 v136, v136
    v_exp_f32 v137, v137
    v_exp_f32 v138, v138
    v_exp_f32 v139, v139
    v_exp_f32 v140, v140
    v_exp_f32 v141, v141
    v_exp_f32 v142, v142
    v_exp_f32 v143, v143
    s_nop 2
    v_smfmac_f32_32x32x32_bf16 a[0:15], a[84:87], v[80:87], v12
    v_smfmac_f32_32x32x32_bf16 a[0:15], a[88:91], v[88:95], v12
    v_smfmac_f32_32x32x32_bf16 a[16:31], a[84:87], v[96:103], v12
    v_smfmac_f32_32x32x32_bf16 a[16:31], a[88:91], v[104:111], v12
    v_smfmac_f32_32x32x32_bf16 a[32:47], a[84:87], v[112:119], v12
    v_smfmac_f32_32x32x32_bf16 a[32:47], a[88:91], v[120:127], v12
    v_smfmac_f32_32x32x32_bf16 a[48:63], a[84:87], v[128:135], v12
    v_smfmac_f32_32x32x32_bf16 a[48:63], a[88:91], v[136:143], v12
    s_add_u32 s48, s48, 1024
    s_sub_u32 s51, s51, 1
    s_cmp_lg_u32 s51, 0
    s_cbranch_scc1 L_afb2
    s_nop 15
    s_mul_i32 s43, s40, 4608
    s_add_u32 s43, s43, 140544
    v_add_u32 v72, s43, v10
    v_lshl_add_u32 v73, v1, 2, s43
    v_mov_b32 v74, s50
    ds_write_b128 v72, a[32:35] offset:0
    ds_write_b128 v72, a[36:39] offset:1024
    ds_write_b32 v73, a40 offset:2048
    ds_write_b128 v72, a[48:51] offset:2304
    ds_write_b128 v72, a[52:55] offset:3328
    ds_write_b32 v73, a56 offset:4352
    ds_write_b32 v13, v74
    s_xor_b32 s43, s40, 2
    s_mul_i32 s43, s43, 4608
    s_add_u32 s43, s43, 140544
    v_add_u32 v75, s43, v10
    v_lshl_add_u32 v76, v1, 2, s43
L_ax75:
    ds_read_b32 v6, v14 offset:0
    s_waitcnt lgkmcnt(0)
    v_cmp_gt_u32 vcc, s50, v6
    s_cbranch_vccz L_ax75_x
    s_sub_u32 s47, s47, 1
    s_cmp_lt_i32 s47, 0
    s_cbranch_scc1 L_ax75_x
    s_branch L_ax75
L_ax75_x:
    ds_read_b128 v[48:51], v75 offset:0
    ds_read_b128 v[52:55], v75 offset:1024
    ds_read_b32 v56, v76 offset:2048
    ds_read_b128 v[60:63], v75 offset:2304
    ds_read_b128 v[64:67], v75 offset:3328
    ds_read_b32 v68, v76 offset:4352
    s_branch L_afin
L_chk63:
    ds_read_b32 v20, v0 offset:0
    s_waitcnt lgkmcnt(0)
    v_cmp_gt_u32 vcc, 1, v20
    s_cbranch_vccz L_chk63_x
    s_sub_u32 s47, s47, 1
    s_cmp_lt_i32 s47, 0
    s_cbranch_scc1 L_chk63_x
    s_sleep 2
    s_branch L_chk63
L_chk64:
    ds_read_b32 v20, v0 offset:0
    s_waitcnt lgkmcnt(0)
    v_cmp_gt_u32 vcc, 2, v20
    s_cbranch_vccz L_chk64_x
    s_sub_u32 s47, s47, 1
    s_cmp_lt_i32 s47, 0
    s_cbranch_scc1 L_chk64_x
    s_sleep 2
    s_branch L_chk64
L_chk65:
    ds_read_b32 v20, v0 offset:0
    s_waitcnt lgkmcnt(0)
    v_cmp_gt_u32 vcc, 3, v20
    s_cbranch_vccz L_chk65_x
    s_sub_u32 s47, s47, 1
    s_cmp_lt_i32 s47, 0
    s_cbranch_scc1 L_chk65_x
    s_sleep 2
    s_branch L_chk65
L_chk66:
    ds_read_b32 v20, v0 offset:0
    s_waitcnt lgkmcnt(0)
    v_cmp_gt_u32 vcc, 4, v20
    s_cbranch_vccz L_chk66_x
    s_sub_u32 s47, s47, 1
    s_cmp_lt_i32 s47, 0
    s_cbranch_scc1 L_chk66_x
    s_sleep 2
    s_branch L_chk66
L_chk67:
    ds_read_b32 v20, v0 offset:0
    s_waitcnt lgkmcnt(0)
    v_cmp_gt_u32 vcc, 5, v20
    s_cbranch_vccz L_chk67_x
    s_sub_u32 s47, s47, 1
    s_cmp_lt_i32 s47, 0
    s_cbranch_scc1 L_chk67_x
    s_sleep 2
    s_branch L_chk67
L_qre:
    buffer_load_dwordx4 v[80:83], v10, s[28:31], s63 offen offset:0 sc1
    buffer_load_dwordx4 v[84:87], v10, s[28:31], s63 offen offset:1024 sc1
    buffer_load_dwordx4 v[88:91], v10, s[28:31], s55 offen offset:0 sc1
    buffer_load_dwordx4 v[92:95], v10, s[28:31], s55 offen offset:1024 sc1
    buffer_load_dword v6, v27, s[28:31], s66 offen offset:0 sc1
    buffer_load_dword v7, v27, s[28:31], s66 offen offset:128 sc1
    buffer_load_dword v8, v27, s[28:31], s67 offen offset:0 sc1
    buffer_load_dword v9, v27, s[28:31], s67 offen offset:128 sc1
    s_waitcnt vmcnt(0)
    v_max3_u32 v96, v80, v81, v95
    v_max3_u32 v96, v82, v83, v96
    v_max3_u32 v96, v84, v85, v96
    v_max3_u32 v96, v86, v87, v96
    v_max3_u32 v96, v88, v89, v96
    v_max3_u32 v96, v90, v91, v96
    v_max3_u32 v96, v92, v93, v96
    v_max3_u32 v96, v94, v95, v96
    v_max3_u32 v96, v96, v6, v7
    v_max3_u32 v96, v96, v8, v9
    v_cmp_eq_u32 vcc, -1, v96
    s_cbranch_vccz L_qre_x
    s_sub_u32 s47, s47, 1
    s_cmp_lt_i32 s47, 0
    s_cbranch_scc1 L_qre_x
    s_sleep 1
    s_branch L_qre
L_akc68:
    ds_read_b32 v6, v0 offset:512
    s_waitcnt lgkmcnt(0)
    v_cmp_gt_u32 vcc, s49, v6
    s_cbranch_vccz L_akc68_x
    s_sub_u32 s47, s47, 1
    s_cmp_lt_i32 s47, 0
    s_cbranch_scc1 L_akc68_x
    s_sleep 1
    s_branch L_akc68
L_akc69:
    ds_read_b32 v6, v0 offset:512
    s_waitcnt lgkmcnt(0)
    v_cmp_gt_u32 vcc, s49, v6
    s_cbranch_vccz L_akc69_x
    s_sub_u32 s47, s47, 1
    s_cmp_lt_i32 s47, 0
    s_cbranch_scc1 L_akc69_x
    s_sleep 1
    s_branch L_akc69
L_akc70:
    ds_read_b32 v6, v0 offset:512
    s_waitcnt lgkmcnt(0)
    v_cmp_gt_u32 vcc, s49, v6
    s_cbranch_vccz L_akc70_x
    s_sub_u32 s47, s47, 1
    s_cmp_lt_i32 s47, 0
    s_cbranch_scc1 L_akc70_x
    s_sleep 1
    s_branch L_akc70
L_akc71:
    ds_read_b32 v6, v0 offset:512
    s_waitcnt lgkmcnt(0)
    v_cmp_gt_u32 vcc, s49, v6
    s_cbranch_vccz L_akc71_x
    s_sub_u32 s47, s47, 1
    s_cmp_lt_i32 s47, 0
    s_cbranch_scc1 L_akc71_x
    s_sleep 1
    s_branch L_akc71
L_akc72:
    ds_read_b32 v6, v0 offset:512
    s_waitcnt lgkmcnt(0)
    v_cmp_gt_u32 vcc, s49, v6
    s_cbranch_vccz L_akc72_x
    s_sub_u32 s47, s47, 1
    s_cmp_lt_i32 s47, 0
    s_cbranch_scc1 L_akc72_x
    s_sleep 1
    s_branch L_akc72
L_akc73:
    ds_read_b32 v6, v0 offset:512
    s_waitcnt lgkmcnt(0)
    v_cmp_gt_u32 vcc, 32, v6
    s_cbranch_vccz L_akc73_x
    s_sub_u32 s47, s47, 1
    s_cmp_lt_i32 s47, 0
    s_cbranch_scc1 L_akc73_x
    s_sleep 1
    s_branch L_akc73
L_end:
    s_endpgm
.fill (51200 - (. - recurrent_scan__softmax_full_mha__glu_gated_geglu__prompt_kernel)) / 4, 4, 0xbf800000
.section .rodata,"a"
.p2align 6
.amdhsa_kernel recurrent_scan__softmax_full_mha__glu_gated_geglu__prompt_kernel
  .amdhsa_next_free_vgpr 256
  .amdhsa_next_free_sgpr 102
  .amdhsa_accum_offset 144
  .amdhsa_group_segment_fixed_size 0
  .amdhsa_kernarg_size 80
  .amdhsa_user_sgpr_count 2
  .amdhsa_user_sgpr_kernarg_segment_ptr 1
  .amdhsa_system_sgpr_workgroup_id_x 1
.end_amdhsa_kernel
```
